```python
import torch

def _softmax(x, axis=-1):
    return torch.softmax(x, dim=axis)
def _gelu(x):
    return torch.nn.functional.gelu(x, approximate="tanh")
def _silu(x):
    return torch.nn.functional.silu(x)
def _sigmoid(x):
    return torch.sigmoid(x)
def _layernorm(x, axis=-1, eps=1e-5):
    m = x.mean(dim=axis, keepdim=True)
    v = x.var(dim=axis, keepdim=True, unbiased=False)
    return (x - m) / torch.sqrt(v + eps)
def _scatter_add(tgt, idx, src, axis=0):
    return tgt.clone().index_add_(axis, idx, src)
def _segment_sum(src, seg, n):
    out = torch.zeros((n,) + src.shape[1:], dtype=src.dtype)
    return out.index_add_(0, seg, src)
def _pad(x, pw):
    flat = tuple(v for pair in reversed(pw) for v in pair)
    return torch.nn.functional.pad(x, flat)

kernel_name = 'concat_heads__ssm_conv_s4d__mha_block__prompt'

def setup_inputs():

    _w = (lambda a: (lambda t: t.to(torch.bfloat16) if t.is_floating_point() else t)(torch.as_tensor(a)))
    def _A_setup():
        Bsz, L, D, N = 1, 2048, 640, 128
        return {
            "u": _w((lambda *s: torch.randn(*s, dtype=torch.bfloat16) * 0.05)(Bsz, L, D)),
            "log_A_real": _w((lambda *s: torch.randn(*s, dtype=torch.bfloat16) * 3.2)(D, N) * 0.5),
            "A_imag": _w((lambda *s: torch.randn(*s, dtype=torch.bfloat16) * 0.1)(D, N) * 3.14),
            "C_real": _w((lambda *s: torch.randn(*s, dtype=torch.bfloat16) * 1.6)(D, N) / N ** 0.5),
            "C_imag": _w((lambda *s: torch.randn(*s, dtype=torch.bfloat16) * 1.6)(D, N) / N ** 0.5),
            "log_dt": _w((lambda *s: torch.randn(*s, dtype=torch.bfloat16) * 0.1)(D) * 0.5 - 4.0),
            "D_skip": _w((lambda *s: torch.randn(*s, dtype=torch.bfloat16) * 0.1)(D)),
        }
    _A_in = _A_setup()

    def _B_setup():
        B, S, D, H = 1, 2048, 640, 32
        return {
            "x": _w((lambda *s: torch.randn(*s, dtype=torch.bfloat16) * 0.2)(B, S, D)),
            "wqkv": _w((lambda *s: torch.randn(*s, dtype=torch.bfloat16) * 0.2)(D, 3 * D)),
            "wo": _w((lambda *s: torch.randn(*s, dtype=torch.bfloat16) * 0.05)(D, D)),
        }
    _B_in = _B_setup()

    return {
        "A_u": _A_in["u"],
        "A_log_A_real": _A_in["log_A_real"],
        "A_A_imag": _A_in["A_imag"],
        "A_C_real": _A_in["C_real"],
        "A_C_imag": _A_in["C_imag"],
        "A_log_dt": _A_in["log_dt"],
        "A_D_skip": _A_in["D_skip"],
        "B_x": _B_in["x"],
        "B_wqkv": _B_in["wqkv"],
        "B_wo": _B_in["wo"],
    }

def reference(A_u, A_log_A_real, A_A_imag, A_C_real, A_C_imag, A_log_dt, A_D_skip, B_x, B_wqkv, B_wo):
    def _A_ref(u, log_A_real, A_imag, C_real, C_imag, log_dt, D_skip):
        L = u.shape[1]
        dt = torch.exp(log_dt)
        A = -torch.exp(log_A_real) + 1j * A_imag
        C = (C_real + 1j * C_imag) * dt[:, None]
        pos = (lambda x, dt: x.to(dt))(torch.arange(L), log_dt.dtype)
        P = torch.exp((A * dt[:, None])[:, :, None] * pos[None, None, :])
        K = 2.0 * torch.einsum("dn,dnl->dl", C, P).real
        L2 = 2 * L
        u_t = (lambda x, *d: x.permute(*d))(u, 0, 2, 1)
        Kf = (lambda x, *a, **k: torch.fft.rfft(x.float(), *a, **k))(K, L2)
        Uf = (lambda x, *a, **k: torch.fft.rfft(x.float(), *a, **k))(u_t, L2)
        y = (lambda x, *a, **k: torch.fft.irfft(x, *a, **k).to(torch.bfloat16))(Uf * Kf[None, :, :], L2)[:, :, :L]
        y = (lambda x, *d: x.permute(*d))(y, 0, 2, 1)
        return y + u * D_skip[None, None, :]

    def _B_ref(x, wqkv, wo):
        B, S, D = x.shape
        H = 32
        Dh = D // H
        qkv = (lambda x, *d: x.permute(*d))((x @ wqkv).reshape(B, S, 3, H, Dh), 2, 0, 3, 1, 4)
        q, k, v = qkv[0], qkv[1], qkv[2]
        scores = torch.einsum("bhqd,bhkd->bhqk", q, k) * (Dh ** -0.5)
        p = _softmax(scores, axis=-1)
        o = torch.einsum("bhqk,bhkd->bhqd", p, v)
        return (lambda x, *d: x.permute(*d))(o, 0, 2, 1, 3).reshape(B, S, D) @ wo

    a = _A_ref(A_u, A_log_A_real, A_A_imag, A_C_real, A_C_imag, A_log_dt, A_D_skip)
    b = _B_ref(B_x, B_wqkv, B_wo)
    return torch.concatenate([a, b], axis=-1)
```

```asm
; @launch grid=(256,1,1) block=(512,1,1) lds=163840
.amdgcn_target "amdgcn-amd-amdhsa--gfx950"
.text
.globl concat_heads__ssm_conv_s4d__mha_block__prompt_kernel
.p2align 8
.type concat_heads__ssm_conv_s4d__mha_block__prompt_kernel,@function
concat_heads__ssm_conv_s4d__mha_block__prompt_kernel:
    s_cmp_ge_u32 s2, 256
    s_cbranch_scc1 L_end
    s_load_dwordx16 s[64:79], s[0:1], 0
    s_load_dwordx8 s[80:87], s[0:1], 64
    s_load_dwordx2 s[88:89], s[0:1], 96
    v_lshrrev_b32 v1, 6, v0
    v_and_b32 v2, 63, v0
    v_readfirstlane_b32 s16, v1
    s_and_b32 s17, s2, 7
    s_lshr_b32 s18, s2, 3
    s_cmp_lg_u32 s16, 7
    s_cbranch_scc1 L_nopf
    s_cmp_ge_u32 s18, (L_code_end-concat_heads__ssm_conv_s4d__mha_block__prompt_kernel)/1024
    s_cbranch_scc1 L_nopf
    s_getpc_b64 s[22:23]
L_pc:
    s_lshl_b32 s24, s18, 10
    s_sub_u32 s22, s22, L_pc-concat_heads__ssm_conv_s4d__mha_block__prompt_kernel
    s_subb_u32 s23, s23, 0
    v_lshl_add_u32 v4, v2, 4, s24
    v_mov_b32 v5, s23
    v_add_co_u32 v4, vcc, s22, v4
    s_nop 1
    v_addc_co_u32 v5, vcc, 0, v5, vcc
    global_load_dwordx4 v[220:223], v[4:5], off
L_nopf:
    s_and_b32 s51, s16, 3
    s_lshr_b32 s48, s16, 2
    s_mul_i32 s52, s17, 20
    s_add_u32 s52, s52, s18
    s_lshl_b32 s52, s52, 2
    s_add_u32 s52, s52, s51
    s_lshl_b32 s22, s52, 8
    v_lshl_add_u32 v6, v2, 2, s22
    s_lshl_b32 s22, s52, 1
    v_mov_b32 v7, s22
    v_lshlrev_b32 v224, 4, v2
    s_mov_b32 s36, 0
    s_mov_b32 s47, 0
    s_cmp_ge_u32 s18, 20
    s_cbranch_scc1 L_e_np
    s_waitcnt lgkmcnt(0)
    global_load_dword v152, v6, s[66:67] nt
    global_load_dword v153, v6, s[68:69] nt
    global_load_dword v154, v6, s[70:71] nt
    global_load_dword v155, v6, s[72:73] nt
    global_load_ushort v156, v7, s[74:75]
    global_load_ushort v233, v7, s[76:77]
L_e_np:
    s_lshr_b32 s20, s17, 1
    s_lshl_b32 s20, s20, 2
    s_and_b32 s24, s17, 1
    s_and_b32 s22, s18, 3
    s_lshr_b32 s23, s18, 2
    s_lshl_b32 s21, s24, 3
    s_add_u32 s21, s21, s23
    s_lshl_b32 s24, s24, 1
    s_cmp_ge_u32 s18, 28
    s_cselect_b32 s21, 7, s21
    s_cselect_b32 s24, s24, 0
    s_add_u32 s22, s22, s24
    s_add_u32 s20, s20, s22
    s_add_u32 s22, s20, s21
    s_and_b32 s22, s22, 3
    s_mov_b32 s58, 1967350288
    s_mov_b32 s59, 152
    s_cmp_eq_u32 s22, 1
    s_cselect_b32 s58, 1683124993, s58
    s_cselect_b32 s59, 137, s59
    s_cmp_eq_u32 s22, 2
    s_cselect_b32 s58, 2468709392, s58
    s_cselect_b32 s59, 118, s59
    s_cmp_eq_u32 s22, 3
    s_cselect_b32 s58, 2184484097, s58
    s_cselect_b32 s59, 103, s59
    v_lshrrev_b32 v8, 3, v2
    v_and_b32 v9, 7, v2
    v_lshrrev_b32 v5, 1, v8
    s_and_b32 s22, s51, 1
    s_lshl_b32 s22, s22, 2
    v_add_u32 v5, s22, v5
    v_xor_b32 v4, v9, v5
    v_lshlrev_b32 v4, 4, v4
    v_mul_u32_u24 v3, 2560, v8
    v_add_u32 v240, v3, v4
    s_lshl_b32 s56, s20, 3
    s_add_u32 s56, s56, s51
    s_mul_i32 s56, s56, 20480
    v_lshrrev_b32 v3, 4, v2
    v_bfe_u32 v4, v2, 2, 2
    v_xor_b32 v4, v4, v3
    v_lshlrev_b32 v4, 6, v4
    v_and_b32 v5, 3, v2
    v_lshlrev_b32 v5, 4, v5
    v_mul_u32_u24 v3, 3840, v3
    v_add3_u32 v244, v3, v4, v5
    s_lshl_b32 s57, s21, 8
    s_mul_i32 s22, s51, 15360
    s_add_u32 s57, s57, s22
    s_lshl_b32 s99, s51, 10
    v_add_u32 v241, 1280, v240
    v_add_u32 v245, 61440, v244
    v_add_u32 v242, 81920, v240
    v_add_u32 v246, 122880, v244
    v_add_u32 v243, 83200, v240
    v_add_u32 v247, 184320, v244
    s_waitcnt lgkmcnt(0)
    s_mov_b32 s60, s78
    s_and_b32 s61, s79, 0xffff
    s_mov_b32 s62, 2621440
    s_mov_b32 s63, 0x20000
    s_mov_b32 s8, s80
    s_and_b32 s9, s81, 0xffff
    s_mov_b32 s10, 2457600
    s_mov_b32 s11, 0x20000
    s_mov_b32 s12, s88
    s_and_b32 s13, s89, 0xffff
    s_mov_b32 s14, 20971520
    s_mov_b32 s15, 0x20000
    s_cmp_ge_u32 s18, 30
    s_cbranch_scc1 L_e_tr
    s_cmp_lt_u32 s18, 20
    s_cselect_b32 s22, 1, 0
    s_cmp_lg_u32 s22, s48
    s_cbranch_scc1 L_e_x
    s_cmp_eq_u32 s48, 1
    s_cbranch_scc1 L_g_pro
    s_barrier
L_g_pro:
    s_and_b32 s43, s58, 15
    s_lshr_b64 s[58:59], s[58:59], 4
    s_lshl_b32 s100, s43, 7
    s_add_u32 s100, s100, s56
    s_mul_i32 s101, s43, 245760
    s_add_u32 s101, s101, s57
    s_add_u32 m0, s99, 0
    s_nop 0
    buffer_load_dwordx4 v240, s[60:63], s100 offen  lds
    s_add_u32 m0, s99, 16384
    s_nop 0
    buffer_load_dwordx4 v244, s[8:11], s101 offen  lds
    s_add_u32 m0, s99, 4096
    s_nop 0
    buffer_load_dwordx4 v241, s[60:63], s100 offen  lds
    s_add_u32 m0, s99, 20480
    s_nop 0
    buffer_load_dwordx4 v245, s[8:11], s101 offen  lds
    s_add_u32 m0, s99, 8192
    s_nop 0
    buffer_load_dwordx4 v242, s[60:63], s100 offen  lds
    s_add_u32 m0, s99, 24576
    s_nop 0
    buffer_load_dwordx4 v246, s[8:11], s101 offen  lds
    s_add_u32 m0, s99, 12288
    s_nop 0
    buffer_load_dwordx4 v243, s[60:63], s100 offen  lds
    s_add_u32 m0, s99, 28672
    s_nop 0
    buffer_load_dwordx4 v247, s[8:11], s101 offen  lds
    s_add_u32 s99, s99, 32768
    s_lshr_b32 s43, s99, 15
    s_cmp_eq_u32 s43, 3
    s_cselect_b32 s43, 32768, 0
    s_add_u32 s99, s99, s43
    s_cmp_ge_u32 s99, 163840
    s_cselect_b32 s43, 163840, 0
    s_sub_u32 s99, s99, s43
    s_cmp_eq_u32 s48, 0
    s_cbranch_scc1 L_gemm
    s_and_b32 s43, s58, 15
    s_lshr_b64 s[58:59], s[58:59], 4
    s_lshl_b32 s100, s43, 7
    s_add_u32 s100, s100, s56
    s_mul_i32 s101, s43, 245760
    s_add_u32 s101, s101, s57
    s_add_u32 m0, s99, 0
    s_nop 0
    buffer_load_dwordx4 v240, s[60:63], s100 offen  lds
    s_add_u32 m0, s99, 16384
    s_nop 0
    buffer_load_dwordx4 v244, s[8:11], s101 offen  lds
    s_add_u32 m0, s99, 4096
    s_nop 0
    buffer_load_dwordx4 v241, s[60:63], s100 offen  lds
    s_add_u32 m0, s99, 20480
    s_nop 0
    buffer_load_dwordx4 v245, s[8:11], s101 offen  lds
    s_add_u32 m0, s99, 8192
    s_nop 0
    buffer_load_dwordx4 v242, s[60:63], s100 offen  lds
    s_add_u32 m0, s99, 24576
    s_nop 0
    buffer_load_dwordx4 v246, s[8:11], s101 offen  lds
    s_add_u32 m0, s99, 12288
    s_nop 0
    buffer_load_dwordx4 v243, s[60:63], s100 offen  lds
    s_add_u32 m0, s99, 28672
    s_nop 0
    buffer_load_dwordx4 v247, s[8:11], s101 offen  lds
    s_add_u32 s99, s99, 32768
    s_lshr_b32 s43, s99, 15
    s_cmp_eq_u32 s43, 3
    s_cselect_b32 s43, 32768, 0
    s_add_u32 s99, s99, s43
    s_cmp_ge_u32 s99, 163840
    s_cselect_b32 s43, 163840, 0
    s_sub_u32 s99, s99, s43
    s_branch L_helper
L_e_x:
    s_cmp_eq_u32 s48, 1
    s_cbranch_scc1 L_nn
    s_setprio 2
    s_branch L_kgen
L_e_tr:
    s_lshl_b32 s26, s17, 1
    s_add_u32 s26, s26, s18
    s_sub_u32 s26, s26, 30
    s_lshl_b32 s26, s26, 3
    s_add_u32 s26, s26, s16
    s_lshl_b32 s27, s16, 13
    s_add_u32 s27, s27, 16384
    s_branch L_e_ut
L_nn:
    s_mul_i32 s26, s17, 10
    s_add_u32 s26, s26, s18
    s_mul_i32 s22, s51, 80
    s_add_u32 s26, s26, s22
    s_add_u32 s26, s26, 108
    s_lshl_b32 s27, s51, 13
    s_add_u32 s27, s27, 98304
    s_cmp_lt_u32 s26, 320
    s_cbranch_scc1 L_e_ut
    s_cmp_lg_u32 s26, 368
    s_cbranch_scc1 L_e_eb
    s_memrealtime s[22:23]
    v_mov_b32 v3, 0
    s_waitcnt lgkmcnt(0)
    s_or_b32 s22, s22, 1
    v_mov_b32 v4, s22
    s_mov_b64 exec, 1
    global_store_dword v3, v4, s[86:87] sc1
    s_mov_b64 exec, -1
    s_branch L_e_eb
L_e_ut:
    s_mov_b32 s4, s64
    s_and_b32 s5, s65, 0xffff
    s_mov_b32 s6, 2621440
    s_mov_b32 s7, 0x20000
    v_lshlrev_b32 v4, 4, v9
    v_mul_u32_u24 v3, 1280, v8
    v_add_u32 v3, v3, v4
    s_mov_b32 m0, s27
    s_lshr_b32 s23, s26, 5
    s_and_b32 s28, s26, 31
    s_mul_i32 s24, s28, 81920
    s_lshl_b32 s22, s23, 7
    s_add_u32 s24, s24, s22
    s_mov_b32 s30, 0
L_ut_i:
    buffer_load_dwordx4 v3, s[4:7], s24 offen nt lds
    s_add_u32 m0, m0, 1024
    s_add_u32 s24, s24, 10240
    s_add_u32 s30, s30, 1
    s_cmp_lt_u32 s30, 8
    s_cbranch_scc1 L_ut_i
    s_cmp_ge_u32 s18, 30
    s_cbranch_scc1 L_utile
L_e_eb:
    s_barrier
L_helper:
    s_mov_b32 s33, 0
    s_cmp_ge_u32 s18, 20
    s_cbranch_scc1 L_h_tr
    s_lshr_b32 s36, s52, 2
    s_lshl_b32 s36, s36, 7
    s_lshl_b32 s22, s51, 2
    s_add_u32 s36, s36, s22
    s_add_u32 s36, s36, 17956864
    s_lshr_b32 s22, s52, 6
    s_lshl_b32 s22, s22, 7
    s_add_u32 s22, s22, 17825792
    v_and_b32 v4, 31, v2
    v_lshl_add_u32 v8, v4, 2, s22
    s_mul_i32 s26, s51, 22784
    s_add_u32 s26, s26, 65536
    s_mul_i32 s27, s52, 4352
    s_add_u32 s27, s27, 11534336
    s_add_u32 s29, s26, 18560
    s_mov_b32 s33, 5
    s_lshr_b64 s[58:59], s[58:59], 4
    s_add_u32 s99, s99, 32768
    s_lshr_b32 s22, s99, 15
    s_cmp_eq_u32 s22, 3
    s_cselect_b32 s22, 32768, 0
    s_add_u32 s99, s99, s22
    s_cmp_ge_u32 s99, 163840
    s_cselect_b32 s22, 163840, 0
    s_sub_u32 s99, s99, s22
    s_setprio 1
L_kgen:
    s_lshl_b32 s28, s16, 13
    s_add_u32 s28, s28, 98304
    v_bfe_u32 v3, v2, 4, 1
    v_lshlrev_b32 v3, 4, v3
    v_mov_b32 v4, 0x3f80
    v_lshlrev_b32 v3, v3, v4
    v_and_b32 v4, 15, v2
    v_lshrrev_b32 v5, 5, v2
    v_lshlrev_b32 v5, 2, v5
    v_sub_u32 v4, v4, v5
    v_cmp_eq_u32 vcc, 0, v4
    s_nop 1
    v_cndmask_b32 v104, 0, v3, vcc
    v_cmp_eq_u32 vcc, 1, v4
    s_nop 1
    v_cndmask_b32 v105, 0, v3, vcc
    v_cmp_eq_u32 vcc, 2, v4
    s_nop 1
    v_cndmask_b32 v106, 0, v3, vcc
    v_cmp_eq_u32 vcc, 3, v4
    s_nop 1
    v_cndmask_b32 v107, 0, v3, vcc
    v_cmp_eq_u32 vcc, 8, v4
    s_nop 1
    v_cndmask_b32 v108, 0, v3, vcc
    v_cmp_eq_u32 vcc, 9, v4
    s_nop 1
    v_cndmask_b32 v109, 0, v3, vcc
    v_cmp_eq_u32 vcc, 10, v4
    s_nop 1
    v_cndmask_b32 v110, 0, v3, vcc
    v_cmp_eq_u32 vcc, 11, v4
    s_nop 1
    v_cndmask_b32 v111, 0, v3, vcc
    s_cmp_eq_u32 s48, 1
    s_cbranch_scc1 L_kg_w
    s_waitcnt vmcnt(0)
L_kg_w:
    s_waitcnt vmcnt(16)
    v_lshlrev_b32 v112, 16, v156
    v_mul_f32 v112, 0x3fb8aa3b, v112
    v_exp_f32 v112, v112
    s_lshl_b32 s22, s48, 4
    v_cvt_pk_bf16_f32 v112, v112, v112
    v_and_b32 v112, 0xffff0000, v112
    v_lshlrev_b32 v152, s22, v152
    v_lshlrev_b32 v153, s22, v153
    v_and_b32 v113, 0xffff0000, v152
    v_mul_f32 v113, 0x3fb8aa3b, v113
    v_exp_f32 v113, v113
    v_and_b32 v114, 0xffff0000, v153
    v_lshlrev_b32 v154, s22, v154
    v_cvt_pk_bf16_f32 v113, v113, v113
    v_lshlrev_b32 v155, s22, v155
    v_and_b32 v113, 0xffff0000, v113
    v_mul_f32 v113, v113, v112
    v_mul_f32 v114, v114, v112
    v_mul_f32 v113, 0xbfb8aa3b, v113
    v_mul_f32 v114, 0.15915494, v114
    v_and_b32 v16, 0xffff0000, v154
    v_and_b32 v17, 0xffff0000, v155
    v_mul_f32 v16, v16, v112
    v_mul_f32 v17, v17, v112
    v_add_f32 v16, v16, v16
    v_add_f32 v17, v17, v17
    v_mul_f32 v116, 0x41000000, v113
    v_mul_f32 v117, 0x41000000, v114
    v_exp_f32 v116, v116
    v_fract_f32 v117, v117
    v_cos_f32 v126, v117
    v_sin_f32 v127, v117
    v_mul_f32 v126, v126, v116
    v_mul_f32 v127, v127, v116
    v_mul_f32 v116, 0x43000000, v113
    v_mul_f32 v117, 0x43000000, v114
    v_exp_f32 v116, v116
    v_fract_f32 v117, v117
    v_cos_f32 v130, v117
    v_sin_f32 v131, v117
    v_mul_f32 v130, v130, v116
    v_mul_f32 v131, v131, v116
    v_mul_f32 v116, 0x3f800000, v113
    v_mul_f32 v117, 0x3f800000, v114
    v_exp_f32 v116, v116
    v_fract_f32 v117, v117
    v_cos_f32 v124, v117
    v_sin_f32 v125, v117
    v_mul_f32 v124, v124, v116
    v_mul_f32 v125, v125, v116
    v_mul_f32 v116, 0x43800000, v113
    v_mul_f32 v117, 0x43800000, v114
    v_exp_f32 v116, v116
    v_fract_f32 v117, v117
    v_cos_f32 v128, v117
    v_sin_f32 v129, v117
    v_mul_f32 v128, v128, v116
    v_mul_f32 v129, v129, v116
    v_cvt_pk_bf16_f32 v160, 1.0, v130
    v_cvt_pk_bf16_f32 v176, 0, v131
    v_pk_mul_f32 v[122:123], v[130:131], v[126:127] op_sel:[0,0] op_sel_hi:[1,0]
    v_pk_fma_f32 v[130:131], v[130:131], v[126:127], v[122:123] op_sel:[1,1,0] op_sel_hi:[0,1,1] neg_lo:[0,1,0]
    v_cvt_pk_bf16_f32 v161, v126, v130
    v_cvt_pk_bf16_f32 v177, v127, v131
    v_pk_mul_f32 v[120:121], v[126:127], v[126:127] op_sel:[0,0] op_sel_hi:[1,0]
    v_pk_mul_f32 v[122:123], v[130:131], v[126:127] op_sel:[0,0] op_sel_hi:[1,0]
    v_pk_fma_f32 v[132:133], v[126:127], v[126:127], v[120:121] op_sel:[1,1,0] op_sel_hi:[0,1,1] neg_lo:[0,1,0]
    v_pk_fma_f32 v[130:131], v[130:131], v[126:127], v[122:123] op_sel:[1,1,0] op_sel_hi:[0,1,1] neg_lo:[0,1,0]
    v_cvt_pk_bf16_f32 v162, v132, v130
    v_cvt_pk_bf16_f32 v178, v133, v131
    v_pk_mul_f32 v[120:121], v[132:133], v[126:127] op_sel:[0,0] op_sel_hi:[1,0]
    v_pk_mul_f32 v[122:123], v[130:131], v[126:127] op_sel:[0,0] op_sel_hi:[1,0]
    v_pk_fma_f32 v[132:133], v[132:133], v[126:127], v[120:121] op_sel:[1,1,0] op_sel_hi:[0,1,1] neg_lo:[0,1,0]
    v_pk_fma_f32 v[130:131], v[130:131], v[126:127], v[122:123] op_sel:[1,1,0] op_sel_hi:[0,1,1] neg_lo:[0,1,0]
    v_cvt_pk_bf16_f32 v163, v132, v130
    v_cvt_pk_bf16_f32 v179, v133, v131
    v_pk_mul_f32 v[120:121], v[132:133], v[126:127] op_sel:[0,0] op_sel_hi:[1,0]
    v_pk_mul_f32 v[122:123], v[130:131], v[126:127] op_sel:[0,0] op_sel_hi:[1,0]
    v_pk_fma_f32 v[132:133], v[132:133], v[126:127], v[120:121] op_sel:[1,1,0] op_sel_hi:[0,1,1] neg_lo:[0,1,0]
    v_pk_fma_f32 v[130:131], v[130:131], v[126:127], v[122:123] op_sel:[1,1,0] op_sel_hi:[0,1,1] neg_lo:[0,1,0]
    v_cvt_pk_bf16_f32 v164, v132, v130
    v_cvt_pk_bf16_f32 v180, v133, v131
    v_pk_mul_f32 v[120:121], v[132:133], v[126:127] op_sel:[0,0] op_sel_hi:[1,0]
    v_pk_mul_f32 v[122:123], v[130:131], v[126:127] op_sel:[0,0] op_sel_hi:[1,0]
    v_pk_fma_f32 v[132:133], v[132:133], v[126:127], v[120:121] op_sel:[1,1,0] op_sel_hi:[0,1,1] neg_lo:[0,1,0]
    v_pk_fma_f32 v[130:131], v[130:131], v[126:127], v[122:123] op_sel:[1,1,0] op_sel_hi:[0,1,1] neg_lo:[0,1,0]
    v_cvt_pk_bf16_f32 v165, v132, v130
    v_cvt_pk_bf16_f32 v181, v133, v131
    v_pk_mul_f32 v[120:121], v[132:133], v[126:127] op_sel:[0,0] op_sel_hi:[1,0]
    v_pk_mul_f32 v[122:123], v[130:131], v[126:127] op_sel:[0,0] op_sel_hi:[1,0]
    v_pk_fma_f32 v[132:133], v[132:133], v[126:127], v[120:121] op_sel:[1,1,0] op_sel_hi:[0,1,1] neg_lo:[0,1,0]
    v_pk_fma_f32 v[130:131], v[130:131], v[126:127], v[122:123] op_sel:[1,1,0] op_sel_hi:[0,1,1] neg_lo:[0,1,0]
    v_cvt_pk_bf16_f32 v166, v132, v130
    v_cvt_pk_bf16_f32 v182, v133, v131
    v_pk_mul_f32 v[120:121], v[132:133], v[126:127] op_sel:[0,0] op_sel_hi:[1,0]
    v_pk_mul_f32 v[122:123], v[130:131], v[126:127] op_sel:[0,0] op_sel_hi:[1,0]
    v_pk_fma_f32 v[132:133], v[132:133], v[126:127], v[120:121] op_sel:[1,1,0] op_sel_hi:[0,1,1] neg_lo:[0,1,0]
    v_pk_fma_f32 v[130:131], v[130:131], v[126:127], v[122:123] op_sel:[1,1,0] op_sel_hi:[0,1,1] neg_lo:[0,1,0]
    v_cvt_pk_bf16_f32 v167, v132, v130
    v_cvt_pk_bf16_f32 v183, v133, v131
    v_pk_mul_f32 v[120:121], v[132:133], v[126:127] op_sel:[0,0] op_sel_hi:[1,0]
    v_pk_mul_f32 v[122:123], v[130:131], v[126:127] op_sel:[0,0] op_sel_hi:[1,0]
    v_pk_fma_f32 v[132:133], v[132:133], v[126:127], v[120:121] op_sel:[1,1,0] op_sel_hi:[0,1,1] neg_lo:[0,1,0]
    v_pk_fma_f32 v[130:131], v[130:131], v[126:127], v[122:123] op_sel:[1,1,0] op_sel_hi:[0,1,1] neg_lo:[0,1,0]
    v_cvt_pk_bf16_f32 v168, v132, v130
    v_cvt_pk_bf16_f32 v184, v133, v131
    v_pk_mul_f32 v[120:121], v[132:133], v[126:127] op_sel:[0,0] op_sel_hi:[1,0]
    v_pk_mul_f32 v[122:123], v[130:131], v[126:127] op_sel:[0,0] op_sel_hi:[1,0]
    v_pk_fma_f32 v[132:133], v[132:133], v[126:127], v[120:121] op_sel:[1,1,0] op_sel_hi:[0,1,1] neg_lo:[0,1,0]
    v_pk_fma_f32 v[130:131], v[130:131], v[126:127], v[122:123] op_sel:[1,1,0] op_sel_hi:[0,1,1] neg_lo:[0,1,0]
    v_cvt_pk_bf16_f32 v169, v132, v130
    v_cvt_pk_bf16_f32 v185, v133, v131
    v_pk_mul_f32 v[120:121], v[132:133], v[126:127] op_sel:[0,0] op_sel_hi:[1,0]
    v_pk_mul_f32 v[122:123], v[130:131], v[126:127] op_sel:[0,0] op_sel_hi:[1,0]
    v_pk_fma_f32 v[132:133], v[132:133], v[126:127], v[120:121] op_sel:[1,1,0] op_sel_hi:[0,1,1] neg_lo:[0,1,0]
    v_pk_fma_f32 v[130:131], v[130:131], v[126:127], v[122:123] op_sel:[1,1,0] op_sel_hi:[0,1,1] neg_lo:[0,1,0]
    v_cvt_pk_bf16_f32 v170, v132, v130
    v_cvt_pk_bf16_f32 v186, v133, v131
    v_pk_mul_f32 v[120:121], v[132:133], v[126:127] op_sel:[0,0] op_sel_hi:[1,0]
    v_pk_mul_f32 v[122:123], v[130:131], v[126:127] op_sel:[0,0] op_sel_hi:[1,0]
    v_pk_fma_f32 v[132:133], v[132:133], v[126:127], v[120:121] op_sel:[1,1,0] op_sel_hi:[0,1,1] neg_lo:[0,1,0]
    v_pk_fma_f32 v[130:131], v[130:131], v[126:127], v[122:123] op_sel:[1,1,0] op_sel_hi:[0,1,1] neg_lo:[0,1,0]
    v_cvt_pk_bf16_f32 v171, v132, v130
    v_cvt_pk_bf16_f32 v187, v133, v131
    v_pk_mul_f32 v[120:121], v[132:133], v[126:127] op_sel:[0,0] op_sel_hi:[1,0]
    v_pk_mul_f32 v[122:123], v[130:131], v[126:127] op_sel:[0,0] op_sel_hi:[1,0]
    v_pk_fma_f32 v[132:133], v[132:133], v[126:127], v[120:121] op_sel:[1,1,0] op_sel_hi:[0,1,1] neg_lo:[0,1,0]
    v_pk_fma_f32 v[130:131], v[130:131], v[126:127], v[122:123] op_sel:[1,1,0] op_sel_hi:[0,1,1] neg_lo:[0,1,0]
    v_cvt_pk_bf16_f32 v172, v132, v130
    v_cvt_pk_bf16_f32 v188, v133, v131
    v_pk_mul_f32 v[120:121], v[132:133], v[126:127] op_sel:[0,0] op_sel_hi:[1,0]
    v_pk_mul_f32 v[122:123], v[130:131], v[126:127] op_sel:[0,0] op_sel_hi:[1,0]
    v_pk_fma_f32 v[132:133], v[132:133], v[126:127], v[120:121] op_sel:[1,1,0] op_sel_hi:[0,1,1] neg_lo:[0,1,0]
    v_pk_fma_f32 v[130:131], v[130:131], v[126:127], v[122:123] op_sel:[1,1,0] op_sel_hi:[0,1,1] neg_lo:[0,1,0]
    v_cvt_pk_bf16_f32 v173, v132, v130
    v_cvt_pk_bf16_f32 v189, v133, v131
    v_pk_mul_f32 v[120:121], v[132:133], v[126:127] op_sel:[0,0] op_sel_hi:[1,0]
    v_pk_mul_f32 v[122:123], v[130:131], v[126:127] op_sel:[0,0] op_sel_hi:[1,0]
    v_pk_fma_f32 v[132:133], v[132:133], v[126:127], v[120:121] op_sel:[1,1,0] op_sel_hi:[0,1,1] neg_lo:[0,1,0]
    v_pk_fma_f32 v[130:131], v[130:131], v[126:127], v[122:123] op_sel:[1,1,0] op_sel_hi:[0,1,1] neg_lo:[0,1,0]
    v_cvt_pk_bf16_f32 v174, v132, v130
    v_cvt_pk_bf16_f32 v190, v133, v131
    v_pk_mul_f32 v[120:121], v[132:133], v[126:127] op_sel:[0,0] op_sel_hi:[1,0]
    v_pk_mul_f32 v[122:123], v[130:131], v[126:127] op_sel:[0,0] op_sel_hi:[1,0]
    v_pk_fma_f32 v[132:133], v[132:133], v[126:127], v[120:121] op_sel:[1,1,0] op_sel_hi:[0,1,1] neg_lo:[0,1,0]
    v_pk_fma_f32 v[130:131], v[130:131], v[126:127], v[122:123] op_sel:[1,1,0] op_sel_hi:[0,1,1] neg_lo:[0,1,0]
    v_cvt_pk_bf16_f32 v175, v132, v130
    v_cvt_pk_bf16_f32 v191, v133, v131
    v_pk_mul_f32 v[116:117], v[16:17], v[124:125] op_sel:[0,0] op_sel_hi:[1,0]
    v_pk_mul_f32 v[118:119], v[16:17], v[126:127] op_sel:[0,0] op_sel_hi:[1,0]
    v_pk_fma_f32 v[20:21], v[16:17], v[124:125], v[116:117] op_sel:[1,1,0] op_sel_hi:[0,1,1] neg_lo:[0,1,0]
    v_pk_fma_f32 v[18:19], v[16:17], v[126:127], v[118:119] op_sel:[1,1,0] op_sel_hi:[0,1,1] neg_lo:[0,1,0]
    v_pk_mul_f32 v[116:117], v[20:21], v[124:125] op_sel:[0,0] op_sel_hi:[1,0]
    v_pk_mul_f32 v[118:119], v[16:17], v[128:129] op_sel:[0,0] op_sel_hi:[1,0]
    v_pk_fma_f32 v[22:23], v[20:21], v[124:125], v[116:117] op_sel:[1,1,0] op_sel_hi:[0,1,1] neg_lo:[0,1,0]
    v_pk_fma_f32 v[48:49], v[16:17], v[128:129], v[118:119] op_sel:[1,1,0] op_sel_hi:[0,1,1] neg_lo:[0,1,0]
    v_pk_mul_f32 v[116:117], v[22:23], v[124:125] op_sel:[0,0] op_sel_hi:[1,0]
    v_pk_mul_f32 v[118:119], v[18:19], v[128:129] op_sel:[0,0] op_sel_hi:[1,0]
    v_pk_fma_f32 v[24:25], v[22:23], v[124:125], v[116:117] op_sel:[1,1,0] op_sel_hi:[0,1,1] neg_lo:[0,1,0]
    v_pk_fma_f32 v[50:51], v[18:19], v[128:129], v[118:119] op_sel:[1,1,0] op_sel_hi:[0,1,1] neg_lo:[0,1,0]
    v_pk_mul_f32 v[116:117], v[24:25], v[124:125] op_sel:[0,0] op_sel_hi:[1,0]
    v_pk_mul_f32 v[118:119], v[48:49], v[128:129] op_sel:[0,0] op_sel_hi:[1,0]
    v_pk_fma_f32 v[26:27], v[24:25], v[124:125], v[116:117] op_sel:[1,1,0] op_sel_hi:[0,1,1] neg_lo:[0,1,0]
    v_pk_fma_f32 v[52:53], v[48:49], v[128:129], v[118:119] op_sel:[1,1,0] op_sel_hi:[0,1,1] neg_lo:[0,1,0]
    v_pk_mul_f32 v[116:117], v[26:27], v[124:125] op_sel:[0,0] op_sel_hi:[1,0]
    v_pk_mul_f32 v[118:119], v[50:51], v[128:129] op_sel:[0,0] op_sel_hi:[1,0]
    v_pk_fma_f32 v[28:29], v[26:27], v[124:125], v[116:117] op_sel:[1,1,0] op_sel_hi:[0,1,1] neg_lo:[0,1,0]
    v_pk_fma_f32 v[54:55], v[50:51], v[128:129], v[118:119] op_sel:[1,1,0] op_sel_hi:[0,1,1] neg_lo:[0,1,0]
    v_pk_mul_f32 v[116:117], v[28:29], v[124:125] op_sel:[0,0] op_sel_hi:[1,0]
    v_pk_mul_f32 v[118:119], v[52:53], v[128:129] op_sel:[0,0] op_sel_hi:[1,0]
    v_pk_fma_f32 v[30:31], v[28:29], v[124:125], v[116:117] op_sel:[1,1,0] op_sel_hi:[0,1,1] neg_lo:[0,1,0]
    v_pk_fma_f32 v[56:57], v[52:53], v[128:129], v[118:119] op_sel:[1,1,0] op_sel_hi:[0,1,1] neg_lo:[0,1,0]
    v_pk_mul_f32 v[116:117], v[30:31], v[124:125] op_sel:[0,0] op_sel_hi:[1,0]
    v_pk_mul_f32 v[118:119], v[54:55], v[128:129] op_sel:[0,0] op_sel_hi:[1,0]
    v_pk_fma_f32 v[32:33], v[30:31], v[124:125], v[116:117] op_sel:[1,1,0] op_sel_hi:[0,1,1] neg_lo:[0,1,0]
    v_pk_fma_f32 v[58:59], v[54:55], v[128:129], v[118:119] op_sel:[1,1,0] op_sel_hi:[0,1,1] neg_lo:[0,1,0]
    v_pk_mul_f32 v[116:117], v[22:23], v[128:129] op_sel:[0,0] op_sel_hi:[1,0]
    v_pk_mul_f32 v[118:119], v[56:57], v[128:129] op_sel:[0,0] op_sel_hi:[1,0]
    v_pk_fma_f32 v[34:35], v[22:23], v[128:129], v[116:117] op_sel:[1,1,0] op_sel_hi:[0,1,1] neg_lo:[0,1,0]
    v_pk_fma_f32 v[60:61], v[56:57], v[128:129], v[118:119] op_sel:[1,1,0] op_sel_hi:[0,1,1] neg_lo:[0,1,0]
    v_pk_mul_f32 v[116:117], v[26:27], v[128:129] op_sel:[0,0] op_sel_hi:[1,0]
    v_pk_mul_f32 v[118:119], v[58:59], v[128:129] op_sel:[0,0] op_sel_hi:[1,0]
    v_pk_fma_f32 v[36:37], v[26:27], v[128:129], v[116:117] op_sel:[1,1,0] op_sel_hi:[0,1,1] neg_lo:[0,1,0]
    v_pk_fma_f32 v[62:63], v[58:59], v[128:129], v[118:119] op_sel:[1,1,0] op_sel_hi:[0,1,1] neg_lo:[0,1,0]
    v_pk_mul_f32 v[116:117], v[30:31], v[128:129] op_sel:[0,0] op_sel_hi:[1,0]
    v_pk_mul_f32 v[118:119], v[60:61], v[128:129] op_sel:[0,0] op_sel_hi:[1,0]
    v_pk_fma_f32 v[38:39], v[30:31], v[128:129], v[116:117] op_sel:[1,1,0] op_sel_hi:[0,1,1] neg_lo:[0,1,0]
    v_pk_fma_f32 v[64:65], v[60:61], v[128:129], v[118:119] op_sel:[1,1,0] op_sel_hi:[0,1,1] neg_lo:[0,1,0]
    v_pk_mul_f32 v[116:117], v[36:37], v[128:129] op_sel:[0,0] op_sel_hi:[1,0]
    v_pk_mul_f32 v[118:119], v[62:63], v[128:129] op_sel:[0,0] op_sel_hi:[1,0]
    v_pk_fma_f32 v[40:41], v[36:37], v[128:129], v[116:117] op_sel:[1,1,0] op_sel_hi:[0,1,1] neg_lo:[0,1,0]
    v_pk_fma_f32 v[66:67], v[62:63], v[128:129], v[118:119] op_sel:[1,1,0] op_sel_hi:[0,1,1] neg_lo:[0,1,0]
    v_pk_mul_f32 v[116:117], v[40:41], v[128:129] op_sel:[0,0] op_sel_hi:[1,0]
    v_pk_mul_f32 v[118:119], v[64:65], v[128:129] op_sel:[0,0] op_sel_hi:[1,0]
    v_pk_fma_f32 v[42:43], v[40:41], v[128:129], v[116:117] op_sel:[1,1,0] op_sel_hi:[0,1,1] neg_lo:[0,1,0]
    v_pk_fma_f32 v[68:69], v[64:65], v[128:129], v[118:119] op_sel:[1,1,0] op_sel_hi:[0,1,1] neg_lo:[0,1,0]
    v_pk_mul_f32 v[116:117], v[66:67], v[128:129] op_sel:[0,0] op_sel_hi:[1,0]
    v_pk_mul_f32 v[118:119], v[68:69], v[128:129] op_sel:[0,0] op_sel_hi:[1,0]
    v_pk_fma_f32 v[44:45], v[66:67], v[128:129], v[116:117] op_sel:[1,1,0] op_sel_hi:[0,1,1] neg_lo:[0,1,0]
    v_pk_fma_f32 v[70:71], v[68:69], v[128:129], v[118:119] op_sel:[1,1,0] op_sel_hi:[0,1,1] neg_lo:[0,1,0]
    v_pk_mul_f32 v[116:117], v[44:45], v[128:129] op_sel:[0,0] op_sel_hi:[1,0]
    v_pk_fma_f32 v[46:47], v[44:45], v[128:129], v[116:117] op_sel:[1,1,0] op_sel_hi:[0,1,1] neg_lo:[0,1,0]
    v_permlane32_swap_b32 v160, v164
    v_permlane32_swap_b32 v161, v165
    v_permlane32_swap_b32 v162, v166
    v_permlane32_swap_b32 v163, v167
    v_permlane32_swap_b32 v168, v172
    v_permlane32_swap_b32 v169, v173
    v_permlane32_swap_b32 v170, v174
    v_permlane32_swap_b32 v171, v175
    v_mfma_f32_32x32x16_bf16 v[72:87], v[160:163], v[104:107], 0
    v_permlane32_swap_b32 v176, v180
    v_permlane32_swap_b32 v177, v181
    v_permlane32_swap_b32 v178, v182
    v_permlane32_swap_b32 v179, v183
    v_permlane32_swap_b32 v184, v188
    v_permlane32_swap_b32 v185, v189
    v_permlane32_swap_b32 v186, v190
    v_permlane32_swap_b32 v187, v191
    v_cvt_pk_bf16_f32 v112, v16, v40
    v_cvt_pk_bf16_f32 v113, v20, v54
    v_mfma_f32_32x32x16_bf16 v[72:87], v[168:171], v[108:111], v[72:87]
    v_cvt_pk_bf16_f32 v114, v22, v60
    v_cvt_pk_bf16_f32 v115, v24, v62
    v_cvt_pk_bf16_f32 v116, v26, v42
    v_cvt_pk_bf16_f32 v117, v28, v58
    v_cvt_pk_bf16_f32 v118, v30, v64
    v_cvt_pk_bf16_f32 v119, v32, v66
    v_cvt_pk_bf16_f32 v120, v48, v68
    v_cvt_pk_bf16_f32 v121, v34, v44
    v_cvt_pk_bf16_f32 v122, v36, 0
    v_cvt_pk_bf16_f32 v123, v52, 0
    v_mfma_f32_32x32x16_bf16 v[88:103], v[164:167], v[104:107], 0
    v_cvt_pk_bf16_f32 v124, v36, v70
    v_cvt_pk_bf16_f32 v125, v38, v46
    v_cvt_pk_bf16_f32 v126, v50, 0
    v_cvt_pk_bf16_f32 v127, v56, 0
    v_cvt_pk_bf16_f32 v128, -v17, -v41
    v_cvt_pk_bf16_f32 v129, -v21, -v55
    v_cvt_pk_bf16_f32 v130, -v23, -v61
    v_cvt_pk_bf16_f32 v131, -v25, -v63
    v_cvt_pk_bf16_f32 v132, -v27, -v43
    v_cvt_pk_bf16_f32 v133, -v29, -v59
    v_mfma_f32_32x32x16_bf16 v[88:103], v[172:175], v[108:111], v[88:103]
    v_cvt_pk_bf16_f32 v134, -v31, -v65
    v_cvt_pk_bf16_f32 v135, -v33, -v67
    v_cvt_pk_bf16_f32 v136, -v49, -v69
    v_cvt_pk_bf16_f32 v137, -v35, -v45
    v_cvt_pk_bf16_f32 v138, -v37, 0
    v_cvt_pk_bf16_f32 v139, -v53, 0
    v_cvt_pk_bf16_f32 v140, -v37, -v71
    v_cvt_pk_bf16_f32 v141, -v39, -v47
    v_cvt_pk_bf16_f32 v142, -v51, 0
    v_cvt_pk_bf16_f32 v143, -v57, 0
    v_mfma_f32_32x32x16_bf16 v[16:31], v[176:179], v[104:107], 0
    v_cvt_pk_bf16_f32 v160, v72, v73
    v_cvt_pk_bf16_f32 v161, v74, v75
    v_cvt_pk_bf16_f32 v162, v76, v77
    v_cvt_pk_bf16_f32 v163, v78, v79
    v_cvt_pk_bf16_f32 v168, v80, v81
    v_cvt_pk_bf16_f32 v169, v82, v83
    v_mfma_f32_32x32x16_bf16 v[16:31], v[184:187], v[108:111], v[16:31]
    v_cvt_pk_bf16_f32 v170, v84, v85
    v_cvt_pk_bf16_f32 v171, v86, v87
    v_cvt_pk_bf16_f32 v164, v88, v89
    v_cvt_pk_bf16_f32 v165, v90, v91
    v_cvt_pk_bf16_f32 v166, v92, v93
    v_cvt_pk_bf16_f32 v167, v94, v95
    v_mfma_f32_32x32x16_bf16 v[32:47], v[180:183], v[104:107], 0
    v_cvt_pk_bf16_f32 v172, v96, v97
    v_cvt_pk_bf16_f32 v173, v98, v99
    v_cvt_pk_bf16_f32 v174, v100, v101
    v_cvt_pk_bf16_f32 v175, v102, v103
    v_permlane32_swap_b32 v112, v116
    v_permlane32_swap_b32 v113, v117
    v_mfma_f32_32x32x16_bf16 v[32:47], v[188:191], v[108:111], v[32:47]
    v_permlane32_swap_b32 v114, v118
    v_permlane32_swap_b32 v115, v119
    v_permlane32_swap_b32 v120, v124
    v_permlane32_swap_b32 v121, v125
    v_permlane32_swap_b32 v122, v126
    v_permlane32_swap_b32 v123, v127
    v_mfma_f32_32x32x16_bf16 v[72:87], v[112:115], v[104:107], 0
    v_permlane32_swap_b32 v128, v132
    v_permlane32_swap_b32 v129, v133
    v_permlane32_swap_b32 v130, v134
    v_permlane32_swap_b32 v131, v135
    v_permlane32_swap_b32 v136, v140
    v_permlane32_swap_b32 v137, v141
    v_mfma_f32_32x32x16_bf16 v[72:87], v[120:123], v[108:111], v[72:87]
    v_permlane32_swap_b32 v138, v142
    v_permlane32_swap_b32 v139, v143
    v_cvt_pk_bf16_f32 v176, v16, v17
    v_cvt_pk_bf16_f32 v177, v18, v19
    v_cvt_pk_bf16_f32 v178, v20, v21
    v_cvt_pk_bf16_f32 v179, v22, v23
    v_mfma_f32_32x32x16_bf16 v[88:103], v[116:119], v[104:107], 0
    v_cvt_pk_bf16_f32 v184, v24, v25
    v_cvt_pk_bf16_f32 v185, v26, v27
    v_cvt_pk_bf16_f32 v186, v28, v29
    v_cvt_pk_bf16_f32 v187, v30, v31
    v_cvt_pk_bf16_f32 v180, v32, v33
    v_cvt_pk_bf16_f32 v181, v34, v35
    v_mfma_f32_32x32x16_bf16 v[88:103], v[124:127], v[108:111], v[88:103]
    v_cvt_pk_bf16_f32 v182, v36, v37
    v_cvt_pk_bf16_f32 v183, v38, v39
    v_cvt_pk_bf16_f32 v188, v40, v41
    v_cvt_pk_bf16_f32 v189, v42, v43
    v_cvt_pk_bf16_f32 v190, v44, v45
    v_cvt_pk_bf16_f32 v191, v46, v47
    v_mfma_f32_32x32x16_bf16 v[16:31], v[128:131], v[104:107], 0
    v_cvt_pk_bf16_f32 v112, v72, v73
    v_cvt_pk_bf16_f32 v113, v74, v75
    v_cvt_pk_bf16_f32 v114, v76, v77
    v_cvt_pk_bf16_f32 v115, v78, v79
    v_cvt_pk_bf16_f32 v120, v80, v81
    v_mfma_f32_32x32x16_bf16 v[16:31], v[136:139], v[108:111], v[16:31]
    v_cvt_pk_bf16_f32 v121, v82, v83
    v_cvt_pk_bf16_f32 v122, v84, v85
    v_cvt_pk_bf16_f32 v123, v86, v87
    s_nop 3
    v_cvt_pk_bf16_f32 v116, v88, v89
    v_mfma_f32_32x32x16_bf16 v[32:47], v[132:135], v[104:107], 0
    v_cvt_pk_bf16_f32 v117, v90, v91
    v_cvt_pk_bf16_f32 v118, v92, v93
    v_cvt_pk_bf16_f32 v119, v94, v95
    v_cvt_pk_bf16_f32 v124, v96, v97
    v_cvt_pk_bf16_f32 v125, v98, v99
    v_mfma_f32_32x32x16_bf16 v[32:47], v[140:143], v[108:111], v[32:47]
    v_cvt_pk_bf16_f32 v126, v100, v101
    v_cvt_pk_bf16_f32 v127, v102, v103
    s_nop 1
    v_mfma_f32_32x32x16_bf16 v[192:207], v[112:115], v[160:163], 0
    v_cvt_pk_bf16_f32 v128, v16, v17
    v_cvt_pk_bf16_f32 v129, v18, v19
    v_cvt_pk_bf16_f32 v130, v20, v21
    v_cvt_pk_bf16_f32 v131, v22, v23
    v_cvt_pk_bf16_f32 v136, v24, v25
    v_mfma_f32_32x32x16_bf16 v[192:207], v[120:123], v[168:171], v[192:207]
    v_cvt_pk_bf16_f32 v137, v26, v27
    v_cvt_pk_bf16_f32 v138, v28, v29
    v_cvt_pk_bf16_f32 v139, v30, v31
    s_nop 3
    v_cvt_pk_bf16_f32 v132, v32, v33
    v_mfma_f32_32x32x16_bf16 v[192:207], v[116:119], v[164:167], v[192:207]
    v_cvt_pk_bf16_f32 v133, v34, v35
    v_cvt_pk_bf16_f32 v134, v36, v37
    v_cvt_pk_bf16_f32 v135, v38, v39
    v_cvt_pk_bf16_f32 v140, v40, v41
    v_cvt_pk_bf16_f32 v141, v42, v43
    v_mfma_f32_32x32x16_bf16 v[192:207], v[124:127], v[172:175], v[192:207]
    v_cvt_pk_bf16_f32 v142, v44, v45
    v_cvt_pk_bf16_f32 v143, v46, v47
    s_nop 1
    v_mfma_f32_32x32x16_bf16 v[192:207], v[128:131], v[176:179], v[192:207]
    v_mfma_f32_32x32x16_bf16 v[192:207], v[136:139], v[184:187], v[192:207]
    v_mfma_f32_32x32x16_bf16 v[192:207], v[132:135], v[180:183], v[192:207]
    v_mfma_f32_32x32x16_bf16 v[192:207], v[140:143], v[188:191], v[192:207]
    s_cmp_eq_u32 s48, 0
    s_cbranch_scc1 L_g_kb
    s_lshr_b64 s[58:59], s[58:59], 4
    s_add_u32 s99, s99, 32768
    s_lshr_b32 s22, s99, 15
    s_cmp_eq_u32 s22, 3
    s_cselect_b32 s22, 32768, 0
    s_add_u32 s99, s99, s22
    s_cmp_ge_u32 s99, 163840
    s_cselect_b32 s22, 163840, 0
    s_sub_u32 s99, s99, s22
    s_setprio 0
    s_mov_b32 s30, 1
    s_waitcnt vmcnt(0)
    s_barrier
    s_branch L_h_ld
L_h_tr:
    s_cmp_ge_u32 s26, 320
    s_cbranch_scc1 L_h_ld0
L_utile:
    s_lshr_b32 s23, s26, 5
    v_xor_b32 v9, v9, v8
    v_lshlrev_b32 v9, 4, v9
    v_mul_u32_u24 v11, 4352, v8
    v_add_u32 v11, v11, v9
    v_lshlrev_b32 v8, 4, v2
    v_add_u32 v8, s27, v8
    v_bfe_u32 v9, v2, 2, 2
    v_lshlrev_b32 v9, 7, v9
    v_lshrrev_b32 v10, 4, v2
    v_lshl_add_u32 v9, v10, 5, v9
    v_and_b32 v10, 3, v2
    v_lshl_add_u32 v9, v10, 3, v9
    v_add_u32 v9, s27, v9
    v_and_b32 v10, 7, v2
    v_lshlrev_b32 v10, 4, v10
    v_lshl_add_u32 v10, v2, 7, v10
    v_add_u32 v10, s27, v10
    s_mul_i32 s23, s23, 278528
    s_lshl_b32 s24, s28, 7
    s_add_u32 s24, s24, s23
    s_add_u32 s24, s24, 11534336
    s_lshl_b32 s29, s26, 2
    s_add_u32 s29, s29, 17825792
    s_waitcnt vmcnt(0)
    ds_read_b64_tr_b16 v[12:13], v9 offset:0
    ds_read_b64_tr_b16 v[14:15], v9 offset:512
    ds_read_b64_tr_b16 v[16:17], v9 offset:1024
    ds_read_b64_tr_b16 v[18:19], v9 offset:1536
    ds_read_b64_tr_b16 v[20:21], v9 offset:2048
    ds_read_b64_tr_b16 v[22:23], v9 offset:2560
    ds_read_b64_tr_b16 v[24:25], v9 offset:3072
    ds_read_b64_tr_b16 v[26:27], v9 offset:3584
    ds_read_b64_tr_b16 v[28:29], v9 offset:4096
    ds_read_b64_tr_b16 v[30:31], v9 offset:4608
    ds_read_b64_tr_b16 v[32:33], v9 offset:5120
    ds_read_b64_tr_b16 v[34:35], v9 offset:5632
    ds_read_b64_tr_b16 v[36:37], v9 offset:6144
    ds_read_b64_tr_b16 v[38:39], v9 offset:6656
    ds_read_b64_tr_b16 v[40:41], v9 offset:7168
    ds_read_b64_tr_b16 v[42:43], v9 offset:7680
    s_waitcnt lgkmcnt(0)
    v_xor_b32 v4, 0, v10
    ds_write_b128 v4, v[12:15]
    v_xor_b32 v4, 16, v10
    ds_write_b128 v4, v[16:19]
    v_xor_b32 v4, 32, v10
    ds_write_b128 v4, v[20:23]
    v_xor_b32 v4, 48, v10
    ds_write_b128 v4, v[24:27]
    v_xor_b32 v4, 64, v10
    ds_write_b128 v4, v[28:31]
    v_xor_b32 v4, 80, v10
    ds_write_b128 v4, v[32:35]
    v_xor_b32 v4, 96, v10
    ds_write_b128 v4, v[36:39]
    v_xor_b32 v4, 112, v10
    ds_write_b128 v4, v[40:43]
    s_waitcnt lgkmcnt(0)
    ds_read_b128 v[12:15], v8 offset:0
    ds_read_b128 v[16:19], v8 offset:1024
    ds_read_b128 v[20:23], v8 offset:2048
    ds_read_b128 v[24:27], v8 offset:3072
    ds_read_b128 v[28:31], v8 offset:4096
    ds_read_b128 v[32:35], v8 offset:5120
    ds_read_b128 v[36:39], v8 offset:6144
    ds_read_b128 v[40:43], v8 offset:7168
    s_waitcnt lgkmcnt(7)
    buffer_store_dwordx4 v[12:15], v11, s[12:15], s24 offen sc1
    s_add_u32 s24, s24, 34816
    s_waitcnt lgkmcnt(6)
    buffer_store_dwordx4 v[16:19], v11, s[12:15], s24 offen sc1
    s_add_u32 s24, s24, 34816
    s_waitcnt lgkmcnt(5)
    buffer_store_dwordx4 v[20:23], v11, s[12:15], s24 offen sc1
    s_add_u32 s24, s24, 34816
    s_waitcnt lgkmcnt(4)
    buffer_store_dwordx4 v[24:27], v11, s[12:15], s24 offen sc1
    s_add_u32 s24, s24, 34816
    s_waitcnt lgkmcnt(3)
    buffer_store_dwordx4 v[28:31], v11, s[12:15], s24 offen sc1
    s_add_u32 s24, s24, 34816
    s_waitcnt lgkmcnt(2)
    buffer_store_dwordx4 v[32:35], v11, s[12:15], s24 offen sc1
    s_add_u32 s24, s24, 34816
    s_waitcnt lgkmcnt(1)
    buffer_store_dwordx4 v[36:39], v11, s[12:15], s24 offen sc1
    s_add_u32 s24, s24, 34816
    s_waitcnt lgkmcnt(0)
    buffer_store_dwordx4 v[40:43], v11, s[12:15], s24 offen sc1
    s_add_u32 s24, s24, 34816
    s_mov_b32 s33, 1
    s_cmp_lt_u32 s18, 30
    s_cbranch_scc1 L_h_ld0
    s_load_dword s19, s[86:87], 0
    s_mov_b32 s50, 0
    v_mov_b32 v222, 0
    s_waitcnt lgkmcnt(0)
L_nonce_1:
    s_cmp_lg_u32 s19, 0
    s_cbranch_scc1 L_nonce_e_2
    global_load_dword v223, v222, s[86:87] sc1
    s_add_u32 s50, s50, 1
    s_waitcnt vmcnt(0)
    v_readfirstlane_b32 s19, v223
    s_cmp_lt_u32 s50, 262144
    s_cbranch_scc1 L_nonce_1
L_nonce_e_2:
    s_waitcnt vmcnt(0)
    v_mov_b32 v4, 0
    v_mov_b32 v5, s19
    s_mov_b64 exec, 1
    buffer_store_dword v5, v4, s[12:15], s29 offen sc1
    s_mov_b64 exec, -1
    s_branch L_tr_back
L_h_ld0:
    s_barrier
    v_mov_b32 v8, 17825792
    s_lshr_b64 s[58:59], s[58:59], 4
    s_add_u32 s99, s99, 32768
    s_lshr_b32 s22, s99, 15
    s_cmp_eq_u32 s22, 3
    s_cselect_b32 s22, 32768, 0
    s_add_u32 s99, s99, s22
    s_cmp_ge_u32 s99, 163840
    s_cselect_b32 s22, 163840, 0
    s_sub_u32 s99, s99, s22
    s_lshr_b64 s[58:59], s[58:59], 4
    s_add_u32 s99, s99, 32768
    s_lshr_b32 s22, s99, 15
    s_cmp_eq_u32 s22, 3
    s_cselect_b32 s22, 32768, 0
    s_add_u32 s99, s99, s22
    s_cmp_ge_u32 s99, 163840
    s_cselect_b32 s22, 163840, 0
    s_sub_u32 s99, s99, s22
    s_lshr_b64 s[58:59], s[58:59], 4
    s_add_u32 s99, s99, 32768
    s_lshr_b32 s22, s99, 15
    s_cmp_eq_u32 s22, 3
    s_cselect_b32 s22, 32768, 0
    s_add_u32 s99, s99, s22
    s_cmp_ge_u32 s99, 163840
    s_cselect_b32 s22, 163840, 0
    s_sub_u32 s99, s99, s22
L_h_ld1:
    s_mov_b32 s30, 0
L_h_ld:
    s_waitcnt vmcnt(16) lgkmcnt(0)
    s_barrier
    s_and_b32 s43, s58, 15
    s_lshr_b64 s[58:59], s[58:59], 4
    s_lshl_b32 s100, s43, 7
    s_add_u32 s100, s100, s56
    s_mul_i32 s101, s43, 245760
    s_add_u32 s101, s101, s57
    s_add_u32 m0, s99, 0
    s_nop 0
    buffer_load_dwordx4 v240, s[60:63], s100 offen  lds
    s_lshl_b32 s37, s17, 2
    s_lshr_b32 s22, s18, 3
    s_add_u32 s37, s37, s22
    s_and_b32 s38, s18, 7
    s_mul_i32 s22, s38, 327680
    s_add_u32 m0, s99, 16384
    s_nop 0
    buffer_load_dwordx4 v244, s[8:11], s101 offen  lds
    s_add_u32 s22, s22, 8388608
    s_lshl_b32 s54, s37, 9
    s_add_u32 s54, s54, s22
    s_lshl_b32 s55, s37, 7
    s_add_u32 s55, s55, s22
    s_add_u32 m0, s99, 4096
    s_nop 0
    buffer_load_dwordx4 v241, s[60:63], s100 offen  lds
    s_add_u32 s55, s55, 16384
    s_mul_i32 s37, s37, 5
    s_lshl_b32 s39, s37, 10
    s_mul_i32 s22, s38, 983040
    s_add_u32 s39, s39, s22
    s_add_u32 m0, s99, 20480
    s_nop 0
    buffer_load_dwordx4 v245, s[8:11], s101 offen  lds
    v_and_b32 v3, 15, v2
    v_bfe_u32 v4, v2, 4, 1
    v_mul_u32_u24 v4, 20480, v4
    v_lshl_add_u32 v237, v3, 3, v4
    v_lshl_add_u32 v4, v3, 4, v4
    s_add_u32 m0, s99, 8192
    s_nop 0
    buffer_load_dwordx4 v242, s[60:63], s100 offen  lds
    v_lshrrev_b32 v3, 5, v2
    v_lshl_add_u32 v236, v3, 8, v4
    s_lshr_b32 s22, s16, 1
    s_and_b32 s23, s16, 1
    s_mul_i32 s44, s22, 2080
    s_add_u32 m0, s99, 24576
    s_nop 0
    buffer_load_dwordx4 v246, s[8:11], s101 offen  lds
    s_lshl_b32 s24, s23, 10
    s_add_u32 s44, s44, s24
    s_add_u32 s44, s44, 1280
    s_add_u32 s45, s44, 8320
    s_add_u32 s46, s44, 16640
    s_add_u32 m0, s99, 12288
    s_nop 0
    buffer_load_dwordx4 v243, s[60:63], s100 offen  lds
    s_add_u32 s24, s22, s37
    s_lshl_b32 s24, s24, 10
    s_mul_i32 s23, s23, 3932160
    s_add_u32 s24, s24, s23
    s_add_u32 s40, s24, 655360
    s_add_u32 m0, s99, 28672
    s_nop 0
    buffer_load_dwordx4 v247, s[8:11], s101 offen  lds
    s_add_u32 s42, s24, 822272
    s_cmp_eq_u32 s22, 0
    s_cselect_b32 s23, 0, 158720
    s_add_u32 s41, s40, s23
    s_add_u32 s41, s41, 4096
    s_add_u32 s99, s99, 32768
    s_lshr_b32 s43, s99, 15
    s_cmp_eq_u32 s43, 3
    s_cselect_b32 s43, 32768, 0
    s_add_u32 s99, s99, s43
    s_cmp_ge_u32 s99, 163840
    s_cselect_b32 s43, 163840, 0
    s_sub_u32 s99, s99, s43
    s_add_u32 s30, s30, 1
    s_cmp_lg_u32 s30, s33
    s_cbranch_scc1 L_h_l1
    s_cmp_lt_u32 s18, 20
    s_cbranch_scc1 L_h_pl
    s_load_dword s19, s[86:87], 0
    s_mov_b32 s50, 0
    v_mov_b32 v222, 0
    s_waitcnt lgkmcnt(0)
L_nonce_3:
    s_cmp_lg_u32 s19, 0
    s_cbranch_scc1 L_nonce_e_4
    global_load_dword v223, v222, s[86:87] sc1
    s_add_u32 s50, s50, 1
    s_waitcnt vmcnt(0)
    v_readfirstlane_b32 s19, v223
    s_cmp_lt_u32 s50, 262144
    s_cbranch_scc1 L_nonce_3
L_nonce_e_4:
    s_waitcnt vmcnt(8)
    v_mov_b32 v10, 0
    v_mov_b32 v11, s19
    s_mov_b64 exec, 1
    buffer_store_dword v11, v10, s[12:15], s29 offen sc1
    s_mov_b64 exec, -1
    s_branch L_h_l1
L_h_pl:
    buffer_load_dword v9, v8, s[12:15], 0 offen sc1
L_h_l1:
    s_cmp_lt_u32 s30, 5
    s_cbranch_scc1 L_h_ld
    s_waitcnt vmcnt(16) lgkmcnt(0)
    s_barrier
    s_and_b32 s43, s58, 15
    s_lshr_b64 s[58:59], s[58:59], 4
    s_lshl_b32 s100, s43, 7
    s_add_u32 s100, s100, s56
    s_mul_i32 s101, s43, 245760
    s_add_u32 s101, s101, s57
    s_add_u32 m0, s99, 0
    s_nop 0
    buffer_load_dwordx4 v240, s[60:63], s100 offen  lds
    s_load_dword s19, s[86:87], 0
    v_mul_u32_u24 v6, 205, v2
    v_lshrrev_b32 v6, 11, v6
    v_mul_u32_u24 v7, 10, v6
    v_sub_u32 v7, v2, v7
    v_lshlrev_b32 v7, 4, v7
    v_mul_u32_u24 v6, 1280, v6
    s_add_u32 m0, s99, 16384
    s_nop 0
    buffer_load_dwordx4 v244, s[8:11], s101 offen  lds
    v_add_u32 v230, v6, v7
    v_add_u32 v250, v6, v230
    v_bfe_u32 v3, v2, 2, 2
    v_lshrrev_b32 v4, 4, v2
    v_and_b32 v5, 3, v2
    v_lshlrev_b32 v5, 3, v5
    v_lshrrev_b32 v6, 2, v2
    s_add_u32 m0, s99, 4096
    s_nop 0
    buffer_load_dwordx4 v241, s[60:63], s100 offen  lds
    v_lshl_add_u32 v6, v6, 7, v5
    s_lshl_b32 s22, s51, 5
    v_add_u32 v253, s22, v6
    v_lshrrev_b32 v6, 5, v2
    v_mul_u32_u24 v6, 12, v6
    v_lshl_add_u32 v6, v4, 2, v6
    v_add_u32 v6, v6, v3
    s_add_u32 m0, s99, 20480
    s_nop 0
    buffer_load_dwordx4 v245, s[8:11], s101 offen  lds
    v_mad_u32_u24 v7, v4, 20, v3
    s_mul_i32 s22, s48, 51200
    s_add_u32 s22, s22, 61056
    v_add_u32 v5, s22, v5
    s_movk_i32 s23, 160
    v_mad_u32_u24 v248, v6, s23, v5
    v_mad_u32_u24 v249, v7, s23, v5
    s_add_u32 m0, s99, 8192
    s_nop 0
    buffer_load_dwordx4 v242, s[60:63], s100 offen  lds
    v_and_b32 v3, 15, v2
    s_mul_i32 s22, s51, 5120
    v_lshl_add_u32 v4, v4, 3, s22
    v_mad_u32_u24 v251, v3, s23, v4
    s_lshl_b32 s24, s17, 2
    s_and_b32 s22, s18, 3
    s_add_u32 s24, s24, s22
    s_add_u32 m0, s99, 24576
    s_nop 0
    buffer_load_dwordx4 v246, s[8:11], s101 offen  lds
    s_lshl_b32 s24, s24, 2
    s_add_u32 s24, s24, s51
    s_mul_i32 s96, s24, 20480
    s_add_u32 s96, s96, 8388608
    s_lshl_b32 s23, s48, 11
    s_add_u32 s97, s96, s23
    s_add_u32 s97, s97, 16384
    s_add_u32 m0, s99, 12288
    s_nop 0
    buffer_load_dwordx4 v243, s[60:63], s100 offen  lds
    s_lshl_b32 s23, s48, 13
    s_add_u32 s96, s96, s23
    s_lshr_b32 s22, s18, 2
    s_add_u32 s22, s22, 8
    s_lshl_b32 s23, s18, 2
    s_add_u32 s23, s23, s51
    s_cmp_eq_u32 s48, 0
    s_cselect_b32 s24, s23, s24
    s_cselect_b32 s22, s17, s22
    s_add_u32 m0, s99, 28672
    s_nop 0
    buffer_load_dwordx4 v247, s[8:11], s101 offen  lds
    s_mul_i32 s98, s24, 40960
    s_mul_i32 s22, s22, 160
    s_add_u32 s98, s98, s22
    s_add_u32 s99, s99, 32768
    s_lshr_b32 s43, s99, 15
    s_cmp_eq_u32 s43, 3
    s_cselect_b32 s43, 32768, 0
    s_add_u32 s99, s99, s43
    s_cmp_ge_u32 s99, 163840
    s_cselect_b32 s43, 163840, 0
    s_sub_u32 s99, s99, s43
    s_add_u32 s30, s30, 1
    s_waitcnt vmcnt(16) lgkmcnt(0)
    s_barrier
    s_and_b32 s43, s58, 15
    s_lshr_b64 s[58:59], s[58:59], 4
    s_lshl_b32 s100, s43, 7
    s_add_u32 s100, s100, s56
    s_mul_i32 s101, s43, 245760
    s_add_u32 s101, s101, s57
    s_add_u32 m0, s99, 0
    s_nop 0
    buffer_load_dwordx4 v240, s[60:63], s100 offen  lds
    v_and_b32 v3, 31, v2
    v_lshlrev_b32 v3, 3, v3
    v_lshrrev_b32 v5, 5, v2
    s_lshl_b32 s49, s48, 10
    s_lshl_b32 s22, s51, 1
    s_add_u32 s22, s22, s48
    s_add_u32 m0, s99, 16384
    s_nop 0
    buffer_load_dwordx4 v244, s[8:11], s101 offen  lds
    s_lshl_b32 s22, s22, 8
    v_add_u32 v231, s22, v3
    v_lshl_add_u32 v232, v5, 12, v231
    v_mul_u32_u24 v225, 4160, v5
    s_add_u32 s22, s49, 1280
    v_add3_u32 v225, v225, v3, s22
    s_add_u32 m0, s99, 4096
    s_nop 0
    buffer_load_dwordx4 v241, s[60:63], s100 offen  lds
    v_xor_b32 v229, 1, v5
    s_add_u32 s22, s22, 8256
    v_mad_u32_u24 v226, v229, s22, v3
    v_add_u32 v226, 64, v226
    v_bfe_u32 v3, v2, 2, 2
    v_lshl_add_u32 v5, v5, 2, v3
    s_add_u32 m0, s99, 20480
    s_nop 0
    buffer_load_dwordx4 v245, s[8:11], s101 offen  lds
    v_and_b32 v4, 3, v2
    v_bfe_u32 v3, v2, 4, 1
    v_lshl_add_u32 v4, v3, 2, v4
    v_cmp_gt_u32 vcc, 5, v4
    v_mul_u32_u24 v4, 2080, v4
    s_add_u32 s22, s49, 11680
    s_add_u32 m0, s99, 8192
    s_nop 0
    buffer_load_dwordx4 v242, s[60:63], s100 offen  lds
    v_add_u32 v4, s22, v4
    v_cndmask_b32 v227, 64, v4, vcc
    v_cndmask_b32 v228, 0, 1, vcc
    v_lshl_add_u32 v227, v5, 3, v227
    s_sub_u32 s24, 106, s16
    s_mul_i32 s94, s24, 7680
    s_add_u32 m0, s99, 24576
    s_nop 0
    buffer_load_dwordx4 v246, s[8:11], s101 offen  lds
    s_lshr_b32 s22, s18, 2
    s_mul_i32 s22, s22, 160
    s_add_u32 s94, s94, s22
    s_mul_i32 s95, s24, 960
    s_add_u32 s95, s95, 61056
    v_and_b32 v3, 3, v2
    s_add_u32 m0, s99, 12288
    s_nop 0
    buffer_load_dwordx4 v243, s[60:63], s100 offen  lds
    v_mul_u32_u24 v10, 4640, v3
    v_bfe_u32 v3, v2, 2, 2
    v_lshl_add_u32 v10, v3, 7, v10
    v_lshrrev_b32 v4, 4, v2
    v_lshl_add_u32 v10, v4, 4, v10
    v_add_u32 v10, s26, v10
    s_add_u32 m0, s99, 28672
    s_nop 0
    buffer_load_dwordx4 v247, s[8:11], s101 offen  lds
    v_and_b32 v3, 15, v2
    v_lshlrev_b32 v3, 3, v3
    v_lshlrev_b32 v11, 4, v4
    v_sub_u32 v11, v11, v3
    v_add_u32 v11, 18680, v11
    v_add_u32 v11, s26, v11
    s_add_u32 s99, s99, 32768
    s_lshr_b32 s43, s99, 15
    s_cmp_eq_u32 s43, 3
    s_cselect_b32 s43, 32768, 0
    s_add_u32 s99, s99, s43
    s_cmp_ge_u32 s99, 163840
    s_cselect_b32 s43, 163840, 0
    s_sub_u32 s99, s99, s43
    s_waitcnt vmcnt(16)
    s_barrier
    s_cmp_lg_u32 s19, 0
    s_cbranch_scc1 L_h_hn
    s_load_dword s19, s[86:87], 0
    s_mov_b32 s50, 0
    v_mov_b32 v222, 0
    s_waitcnt lgkmcnt(0)
L_nonce_5:
    s_cmp_lg_u32 s19, 0
    s_cbranch_scc1 L_nonce_e_6
    global_load_dword v223, v222, s[86:87] sc1
    s_add_u32 s50, s50, 1
    s_waitcnt vmcnt(0)
    v_readfirstlane_b32 s19, v223
    s_cmp_lt_u32 s50, 262144
    s_cbranch_scc1 L_nonce_5
L_nonce_e_6:
L_h_hn:
    v_mov_b32 v220, 129536
    v_mov_b32 v222, 0
    v_mov_b32 v223, 0
    ds_write_b64 v220, v[222:223]
    s_cmp_lt_u32 s18, 20
    s_cbranch_scc1 L_h_k7
    s_waitcnt vmcnt(0) lgkmcnt(0)
    s_barrier
    v_lshrrev_b32 v4, 3, v2
    v_and_b32 v3, 7, v2
    v_lshlrev_b32 v3, 4, v3
    v_mul_u32_u24 v4, 4352, v4
    v_add_u32 v238, v4, v3
    s_mul_i32 s22, s17, 10
    s_add_u32 s22, s22, s16
    s_mul_i32 s22, s22, 34816
    s_lshl_b32 s23, s18, 7
    s_add_u32 s22, s22, s23
    s_add_u32 s21, s22, 11534336
    s_mul_i32 s22, s17, 2560
    s_add_u32 s22, s22, 17956864
    v_min_u32 v3, 19, v2
    v_lshl_add_u32 v239, v3, 7, s22
    v_bfe_u32 v3, v2, 3, 2
    v_lshlrev_b32 v3, 6, v3
    v_and_b32 v4, 7, v2
    s_lshl_b32 s22, s17, 3
    v_add3_u32 v3, v3, v4, s22
    v_cmp_gt_u32 vcc, 32, v2
    v_lshlrev_b32 v3, 7, v3
    v_add_u32 v3, 18022400, v3
    v_cndmask_b32 v239, v3, v239, vcc
    s_branch L_attn
L_h_ids:
    s_mov_b32 s33, 2
    s_branch L_setup
L_h_k7:
    s_sub_u32 s28, s28, 32768
    v_add_u32 v6, s28, v224
    v_cmp_ne_u32 vcc, s19, v9
    s_mov_b32 s31, 0
    ds_read_b128 v[16:19], v6 offset:0
    ds_read_b128 v[20:23], v6 offset:1024
    ds_read_b128 v[24:27], v6 offset:2048
    ds_read_b128 v[28:31], v6 offset:3072
    s_cbranch_vccnz L_h_nu
    buffer_load_dwordx4 v[132:135], v224, s[12:15], s27 offen offset:0 sc1
    buffer_load_dwordx4 v[136:139], v224, s[12:15], s27 offen offset:1024 sc1
    buffer_load_dwordx4 v[140:143], v224, s[12:15], s27 offen offset:2048 sc1
    buffer_load_dwordx4 v[144:147], v224, s[12:15], s27 offen offset:3072 sc1
    s_mov_b32 s31, 1
    s_branch L_h_n2
L_h_nu:
    buffer_load_dword v9, v8, s[12:15], 0 offen sc1
L_h_n2:
    s_waitcnt lgkmcnt(0)
    v_add_f32 v192, v192, v16
    v_add_f32 v193, v193, v17
    v_add_f32 v194, v194, v18
    v_add_f32 v195, v195, v19
    v_add_f32 v196, v196, v20
    v_add_f32 v197, v197, v21
    v_add_f32 v198, v198, v22
    v_add_f32 v199, v199, v23
    v_add_f32 v200, v200, v24
    v_add_f32 v201, v201, v25
    v_add_f32 v202, v202, v26
    v_add_f32 v203, v203, v27
    v_add_f32 v204, v204, v28
    v_add_f32 v205, v205, v29
    v_and_b32 v3, 31, v2
    v_lshrrev_b32 v4, 5, v2
    v_lshlrev_b32 v12, 4, v3
    v_sub_u32 v12, s29, v12
    v_lshlrev_b32 v13, 3, v4
    v_sub_u32 v180, v12, v13
    v_lshlrev_b32 v13, 9, v4
    v_sub_u32 v181, v12, v13
    v_and_b32 v4, 1, v3
    v_cmp_eq_u32 vcc, 0, v4
    v_lshlrev_b32 v3, 2, v3
    v_add_u32 v182, s29, v3
    v_lshlrev_b32 v15, 16, v233
    s_mov_b64 exec, 1
    v_add_f32 v192, v192, v15
    s_mov_b64 exec, -1
    v_cvt_pk_bf16_f32 v208, v195, v194
    v_cvt_pk_bf16_f32 v209, v193, v192
    v_cvt_pk_bf16_f32 v210, v198, v197
    v_cvt_pk_bf16_f32 v211, v196, v196
    v_cvt_pk_bf16_f32 v212, v201, v201
    v_cvt_pk_bf16_f32 v213, v200, v200
    v_cvt_pk_bf16_f32 v214, v200, v199
    v_cvt_pk_bf16_f32 v215, v199, v199
    v_cndmask_b32 v13, v203, v202, vcc
    v_cvt_pk_bf16_f32 v216, v203, v203
    v_cvt_pk_bf16_f32 v217, v203, v13
    v_cvt_pk_bf16_f32 v218, v202, v202
    v_cvt_pk_bf16_f32 v219, v202, v202
    v_cndmask_b32 v13, v205, v204, vcc
    v_cvt_pk_bf16_f32 v220, v205, v205
    v_cvt_pk_bf16_f32 v221, v205, v13
    v_cvt_pk_bf16_f32 v222, v204, v204
    v_cvt_pk_bf16_f32 v223, v204, v204
    v_lshlrev_b32 v5, 3, v2
    v_min_u32 v5, 376, v5
    v_add_u32 v5, s26, v5
    v_mov_b32 v6, 0
    v_mov_b32 v7, 0
    s_cmp_eq_u32 s31, 1
    s_cbranch_scc1 L_h_w4
    s_waitcnt vmcnt(1)
L_h_w4:
    s_waitcnt vmcnt(4)
    s_barrier
    s_cmp_eq_u32 s31, 1
    s_cbranch_scc1 L_h_hu
    s_waitcnt vmcnt(0)
    s_mov_b32 s50, 0
    s_branch L_poll_7_c
L_poll_7:
    buffer_load_dword v9, v8, s[12:15], 0 offen sc1
    s_add_u32 s50, s50, 1
    s_waitcnt vmcnt(0)
L_poll_7_c:
    v_xor_b32 v9, s19, v9
    v_cmp_ne_u32 vcc, 0, v9
    s_cmp_gt_u32 s50, 262144
    s_cbranch_scc1 L_poll_e_8
    s_cbranch_vccnz L_poll_7
L_poll_e_8:
    buffer_load_dwordx4 v[132:135], v224, s[12:15], s27 offen offset:0 sc1
    buffer_load_dwordx4 v[136:139], v224, s[12:15], s27 offen offset:1024 sc1
    buffer_load_dwordx4 v[140:143], v224, s[12:15], s27 offen offset:2048 sc1
    buffer_load_dwordx4 v[144:147], v224, s[12:15], s27 offen offset:3072 sc1
L_h_hu:
    ds_write_b64 v180, v[208:209] offset:4088
    ds_write_b64 v180, v[210:211] offset:3576
    ds_write_b128 v181, v[212:215] offset:3056
    ds_write_b128 v181, v[216:219] offset:2032
    ds_write_b128 v181, v[220:223] offset:1008
    ds_write_b32 v182, v6 offset:4096
    ds_write_b64 v5, v[6:7] offset:0
    ds_write_b64 v5, v[6:7] offset:4640
    ds_write_b64 v5, v[6:7] offset:9280
    ds_write_b64 v5, v[6:7] offset:13920
    s_mul_i32 s27, s52, 4352
    s_add_u32 s27, s27, 11534336
    v_add_u32 v4, s26, v224
    s_waitcnt vmcnt(0)
    ds_write_b128 v4, v[132:135] offset:14304
    v_mov_b32 v28, 0
    v_mov_b32 v20, 0
    s_nop 0
    v_mov_b32_dpp v28, v134 wave_shr:1 row_mask:0xf bank_mask:0xf
    v_mov_b32_dpp v20, v135 wave_shr:1 row_mask:0xf bank_mask:0xf
    v_mov_b32 v21, v132
    v_mov_b32 v22, v133
    v_mov_b32 v23, v134
    ds_write_b128 v4, v[20:23] offset:5024
    v_alignbit_b32 v16, v132, v20, 16
    v_alignbit_b32 v17, v133, v132, 16
    v_alignbit_b32 v18, v134, v133, 16
    v_alignbit_b32 v19, v135, v134, 16
    ds_write_b128 v4, v[16:19] offset:9664
    v_alignbit_b32 v24, v20, v28, 16
    v_mov_b32 v25, v16
    v_mov_b32 v26, v17
    v_mov_b32 v27, v18
    ds_write_b128 v4, v[24:27] offset:384
    ds_write_b128 v4, v[136:139] offset:15328
    v_readlane_b32 s22, v134, 63
    v_readlane_b32 s23, v135, 63
    s_nop 0
    v_mov_b32 v42, s22
    v_mov_b32 v34, s23
    s_nop 0
    v_mov_b32_dpp v42, v138 wave_shr:1 row_mask:0xf bank_mask:0xf
    v_mov_b32_dpp v34, v139 wave_shr:1 row_mask:0xf bank_mask:0xf
    v_mov_b32 v35, v136
    v_mov_b32 v36, v137
    v_mov_b32 v37, v138
    ds_write_b128 v4, v[34:37] offset:6048
    v_alignbit_b32 v30, v136, v34, 16
    v_alignbit_b32 v31, v137, v136, 16
    v_alignbit_b32 v32, v138, v137, 16
    v_alignbit_b32 v33, v139, v138, 16
    ds_write_b128 v4, v[30:33] offset:10688
    v_alignbit_b32 v38, v34, v42, 16
    v_mov_b32 v39, v30
    v_mov_b32 v40, v31
    v_mov_b32 v41, v32
    ds_write_b128 v4, v[38:41] offset:1408
    ds_write_b128 v4, v[140:143] offset:16352
    v_readlane_b32 s22, v138, 63
    v_readlane_b32 s23, v139, 63
    s_nop 0
    v_mov_b32 v56, s22
    v_mov_b32 v48, s23
    s_nop 0
    v_mov_b32_dpp v56, v142 wave_shr:1 row_mask:0xf bank_mask:0xf
    v_mov_b32_dpp v48, v143 wave_shr:1 row_mask:0xf bank_mask:0xf
    v_mov_b32 v49, v140
    v_mov_b32 v50, v141
    v_mov_b32 v51, v142
    ds_write_b128 v4, v[48:51] offset:7072
    v_alignbit_b32 v44, v140, v48, 16
    v_alignbit_b32 v45, v141, v140, 16
    v_alignbit_b32 v46, v142, v141, 16
    v_alignbit_b32 v47, v143, v142, 16
    ds_write_b128 v4, v[44:47] offset:11712
    v_alignbit_b32 v52, v48, v56, 16
    v_mov_b32 v53, v44
    v_mov_b32 v54, v45
    v_mov_b32 v55, v46
    ds_write_b128 v4, v[52:55] offset:2432
    ds_write_b128 v4, v[144:147] offset:17376
    v_readlane_b32 s22, v142, 63
    v_readlane_b32 s23, v143, 63
    s_nop 0
    v_mov_b32 v70, s22
    v_mov_b32 v62, s23
    s_nop 0
    v_mov_b32_dpp v70, v146 wave_shr:1 row_mask:0xf bank_mask:0xf
    v_mov_b32_dpp v62, v147 wave_shr:1 row_mask:0xf bank_mask:0xf
    v_mov_b32 v63, v144
    v_mov_b32 v64, v145
    v_mov_b32 v65, v146
    ds_write_b128 v4, v[62:65] offset:8096
    v_alignbit_b32 v58, v144, v62, 16
    v_alignbit_b32 v59, v145, v144, 16
    v_alignbit_b32 v60, v146, v145, 16
    v_alignbit_b32 v61, v147, v146, 16
    ds_write_b128 v4, v[58:61] offset:12736
    v_alignbit_b32 v66, v62, v70, 16
    v_mov_b32 v67, v58
    v_mov_b32 v68, v59
    v_mov_b32 v69, v60
    ds_write_b128 v4, v[66:69] offset:3456
    s_waitcnt lgkmcnt(0)
    ds_read_b64 v[48:49], v11 offset:3584
    ds_read_b64 v[50:51], v11 offset:3592
    ds_read_b128 v[16:19], v10 offset:0
    ds_read_b64 v[52:53], v11 offset:3072
    ds_read_b64 v[54:55], v11 offset:3080
    ds_read_b128 v[20:23], v10 offset:512
    ds_read_b64 v[56:57], v11 offset:2560
    ds_read_b64 v[58:59], v11 offset:2568
    ds_read_b128 v[24:27], v10 offset:1024
    ds_read_b64 v[60:61], v11 offset:2048
    ds_read_b64 v[62:63], v11 offset:2056
    ds_read_b128 v[28:31], v10 offset:1536
    s_waitcnt lgkmcnt(9)
    v_mfma_f32_16x16x32_bf16 v[148:151], v[16:19], v[48:51], 0
    ds_read_b64 v[64:65], v11 offset:1536
    s_waitcnt lgkmcnt(7)
    v_mfma_f32_16x16x32_bf16 v[152:155], v[16:19], v[52:55], 0
    ds_read_b64 v[66:67], v11 offset:1544
    v_mfma_f32_16x16x32_bf16 v[152:155], v[20:23], v[48:51], v[152:155]
    ds_read_b128 v[32:35], v10 offset:2048
    v_mfma_f32_16x16x32_bf16 v[156:159], v[20:23], v[52:55], 0
    ds_read_b64 v[68:69], v11 offset:1024
    s_waitcnt lgkmcnt(7)
    v_mfma_f32_16x16x32_bf16 v[156:159], v[16:19], v[56:59], v[156:159]
    ds_read_b64 v[70:71], v11 offset:1032
    v_mfma_f32_16x16x32_bf16 v[160:163], v[20:23], v[56:59], 0
    ds_read_b128 v[36:39], v10 offset:2560
    v_mfma_f32_16x16x32_bf16 v[156:159], v[24:27], v[48:51], v[156:159]
    ds_read_b64 v[72:73], v11 offset:512
    v_mfma_f32_16x16x32_bf16 v[160:163], v[24:27], v[52:55], v[160:163]
    ds_read_b64 v[74:75], v11 offset:520
    v_mfma_f32_16x16x32_bf16 v[164:167], v[24:27], v[56:59], 0
    ds_read_b128 v[40:43], v10 offset:3072
    s_waitcnt lgkmcnt(9)
    v_mfma_f32_16x16x32_bf16 v[160:163], v[16:19], v[60:63], v[160:163]
    ds_read_b64 v[76:77], v11 offset:0
    v_mfma_f32_16x16x32_bf16 v[164:167], v[20:23], v[60:63], v[164:167]
    ds_read_b64 v[78:79], v11 offset:8
    v_mfma_f32_16x16x32_bf16 v[168:171], v[24:27], v[60:63], 0
    ds_read_b128 v[44:47], v10 offset:3584
    v_mfma_f32_16x16x32_bf16 v[160:163], v[28:31], v[48:51], v[160:163]
    ds_read_b64 v[112:113], v11 offset:3648
    v_mfma_f32_16x16x32_bf16 v[164:167], v[28:31], v[52:55], v[164:167]
    ds_read_b64 v[114:115], v11 offset:3656
    v_mfma_f32_16x16x32_bf16 v[168:171], v[28:31], v[56:59], v[168:171]
    ds_read_b128 v[80:83], v10 offset:64
    v_mfma_f32_16x16x32_bf16 v[172:175], v[28:31], v[60:63], 0
    ds_read_b64 v[116:117], v11 offset:3136
    s_waitcnt lgkmcnt(13)
    v_mfma_f32_16x16x32_bf16 v[164:167], v[16:19], v[64:67], v[164:167]
    ds_read_b64 v[118:119], v11 offset:3144
    v_mfma_f32_16x16x32_bf16 v[168:171], v[20:23], v[64:67], v[168:171]
    ds_read_b128 v[84:87], v10 offset:576
    v_mfma_f32_16x16x32_bf16 v[172:175], v[24:27], v[64:67], v[172:175]
    ds_read_b64 v[120:121], v11 offset:2624
    v_mfma_f32_16x16x32_bf16 v[176:179], v[28:31], v[64:67], 0
    ds_read_b64 v[122:123], v11 offset:2632
    v_mfma_f32_16x16x32_bf16 v[164:167], v[32:35], v[48:51], v[164:167]
    ds_read_b128 v[88:91], v10 offset:1088
    v_mfma_f32_16x16x32_bf16 v[168:171], v[32:35], v[52:55], v[168:171]
    ds_read_b64 v[124:125], v11 offset:2112
    v_mfma_f32_16x16x32_bf16 v[172:175], v[32:35], v[56:59], v[172:175]
    ds_read_b64 v[126:127], v11 offset:2120
    v_mfma_f32_16x16x32_bf16 v[176:179], v[32:35], v[60:63], v[176:179]
    ds_read_b128 v[92:95], v10 offset:1600
    s_waitcnt lgkmcnt(14)
    v_mfma_f32_16x16x32_bf16 v[168:171], v[16:19], v[68:71], v[168:171]
    ds_read_b64 v[128:129], v11 offset:1600
    v_mfma_f32_16x16x32_bf16 v[172:175], v[20:23], v[68:71], v[172:175]
    ds_read_b64 v[130:131], v11 offset:1608
    v_mfma_f32_16x16x32_bf16 v[176:179], v[24:27], v[68:71], v[176:179]
    ds_read_b128 v[96:99], v10 offset:2112
    v_mfma_f32_16x16x32_bf16 v[168:171], v[36:39], v[48:51], v[168:171]
    ds_read_b64 v[132:133], v11 offset:1088
    v_mfma_f32_16x16x32_bf16 v[172:175], v[36:39], v[52:55], v[172:175]
    ds_read_b64 v[134:135], v11 offset:1096
    v_mfma_f32_16x16x32_bf16 v[176:179], v[36:39], v[56:59], v[176:179]
    ds_read_b128 v[100:103], v10 offset:2624
    s_waitcnt lgkmcnt(14)
    v_mfma_f32_16x16x32_bf16 v[172:175], v[16:19], v[72:75], v[172:175]
    ds_read_b64 v[136:137], v11 offset:576
    v_mfma_f32_16x16x32_bf16 v[176:179], v[20:23], v[72:75], v[176:179]
    ds_read_b64 v[138:139], v11 offset:584
    v_mfma_f32_16x16x32_bf16 v[172:175], v[40:43], v[48:51], v[172:175]
    ds_read_b128 v[104:107], v10 offset:3136
    v_mfma_f32_16x16x32_bf16 v[176:179], v[40:43], v[52:55], v[176:179]
    ds_read_b64 v[140:141], v11 offset:64
    s_waitcnt lgkmcnt(14)
    v_mfma_f32_16x16x32_bf16 v[176:179], v[16:19], v[76:79], v[176:179]
    ds_read_b64 v[142:143], v11 offset:72
    v_mfma_f32_16x16x32_bf16 v[176:179], v[44:47], v[48:51], v[176:179]
    ds_read_b128 v[108:111], v10 offset:3648
    s_mov_b32 s53, 0
.p2align 3
L_cv_9:
    s_waitcnt lgkmcnt(0)
    v_mfma_f32_16x16x32_bf16 v[148:151], v[80:83], v[112:115], v[148:151]
    ds_read_b64 v[48:49], v11 offset:3712
    v_mfma_f32_16x16x32_bf16 v[152:155], v[80:83], v[116:119], v[152:155]
    ds_read_b64 v[50:51], v11 offset:3720
    v_mfma_f32_16x16x32_bf16 v[152:155], v[84:87], v[112:115], v[152:155]
    ds_read_b128 v[16:19], v10 offset:128
    v_mfma_f32_16x16x32_bf16 v[156:159], v[84:87], v[116:119], v[156:159]
    ds_read_b64 v[52:53], v11 offset:3200
    v_mfma_f32_16x16x32_bf16 v[156:159], v[80:83], v[120:123], v[156:159]
    ds_read_b64 v[54:55], v11 offset:3208
    v_mfma_f32_16x16x32_bf16 v[160:163], v[84:87], v[120:123], v[160:163]
    ds_read_b128 v[20:23], v10 offset:640
    v_mfma_f32_16x16x32_bf16 v[156:159], v[88:91], v[112:115], v[156:159]
    ds_read_b64 v[56:57], v11 offset:2688
    v_mfma_f32_16x16x32_bf16 v[160:163], v[88:91], v[116:119], v[160:163]
    ds_read_b64 v[58:59], v11 offset:2696
    v_mfma_f32_16x16x32_bf16 v[164:167], v[88:91], v[120:123], v[164:167]
    ds_read_b128 v[24:27], v10 offset:1152
    v_mfma_f32_16x16x32_bf16 v[160:163], v[80:83], v[124:127], v[160:163]
    ds_read_b64 v[60:61], v11 offset:2176
    v_mfma_f32_16x16x32_bf16 v[164:167], v[84:87], v[124:127], v[164:167]
    ds_read_b64 v[62:63], v11 offset:2184
    v_mfma_f32_16x16x32_bf16 v[168:171], v[88:91], v[124:127], v[168:171]
    ds_read_b128 v[28:31], v10 offset:1664
    v_mfma_f32_16x16x32_bf16 v[160:163], v[92:95], v[112:115], v[160:163]
    ds_read_b64 v[64:65], v11 offset:1664
    v_mfma_f32_16x16x32_bf16 v[164:167], v[92:95], v[116:119], v[164:167]
    ds_read_b64 v[66:67], v11 offset:1672
    v_mfma_f32_16x16x32_bf16 v[168:171], v[92:95], v[120:123], v[168:171]
    ds_read_b128 v[32:35], v10 offset:2176
    v_mfma_f32_16x16x32_bf16 v[172:175], v[92:95], v[124:127], v[172:175]
    ds_read_b64 v[68:69], v11 offset:1152
    v_mfma_f32_16x16x32_bf16 v[164:167], v[80:83], v[128:131], v[164:167]
    ds_read_b64 v[70:71], v11 offset:1160
    v_mfma_f32_16x16x32_bf16 v[168:171], v[84:87], v[128:131], v[168:171]
    ds_read_b128 v[36:39], v10 offset:2688
    v_mfma_f32_16x16x32_bf16 v[172:175], v[88:91], v[128:131], v[172:175]
    ds_read_b64 v[72:73], v11 offset:640
    v_mfma_f32_16x16x32_bf16 v[176:179], v[92:95], v[128:131], v[176:179]
    ds_read_b64 v[74:75], v11 offset:648
    v_mfma_f32_16x16x32_bf16 v[164:167], v[96:99], v[112:115], v[164:167]
    ds_read_b128 v[40:43], v10 offset:3200
    v_mfma_f32_16x16x32_bf16 v[168:171], v[96:99], v[116:119], v[168:171]
    ds_read_b64 v[76:77], v11 offset:128
    v_mfma_f32_16x16x32_bf16 v[172:175], v[96:99], v[120:123], v[172:175]
    ds_read_b64 v[78:79], v11 offset:136
    v_mfma_f32_16x16x32_bf16 v[176:179], v[96:99], v[124:127], v[176:179]
    ds_read_b128 v[44:47], v10 offset:3712
    v_mfma_f32_16x16x32_bf16 v[168:171], v[80:83], v[132:135], v[168:171]
    v_mfma_f32_16x16x32_bf16 v[172:175], v[84:87], v[132:135], v[172:175]
    v_mfma_f32_16x16x32_bf16 v[176:179], v[88:91], v[132:135], v[176:179]
    v_mfma_f32_16x16x32_bf16 v[168:171], v[100:103], v[112:115], v[168:171]
    v_mfma_f32_16x16x32_bf16 v[172:175], v[100:103], v[116:119], v[172:175]
    v_mfma_f32_16x16x32_bf16 v[176:179], v[100:103], v[120:123], v[176:179]
    v_mfma_f32_16x16x32_bf16 v[172:175], v[80:83], v[136:139], v[172:175]
    v_mfma_f32_16x16x32_bf16 v[176:179], v[84:87], v[136:139], v[176:179]
    v_mfma_f32_16x16x32_bf16 v[172:175], v[104:107], v[112:115], v[172:175]
    v_mfma_f32_16x16x32_bf16 v[176:179], v[104:107], v[116:119], v[176:179]
    v_mfma_f32_16x16x32_bf16 v[176:179], v[80:83], v[140:143], v[176:179]
    v_mfma_f32_16x16x32_bf16 v[176:179], v[108:111], v[112:115], v[176:179]
    s_waitcnt lgkmcnt(0)
    v_mfma_f32_16x16x32_bf16 v[148:151], v[16:19], v[48:51], v[148:151]
    ds_read_b64 v[112:113], v11 offset:3776
    v_mfma_f32_16x16x32_bf16 v[152:155], v[16:19], v[52:55], v[152:155]
    ds_read_b64 v[114:115], v11 offset:3784
    v_mfma_f32_16x16x32_bf16 v[152:155], v[20:23], v[48:51], v[152:155]
    ds_read_b128 v[80:83], v10 offset:192
    v_mfma_f32_16x16x32_bf16 v[156:159], v[20:23], v[52:55], v[156:159]
    ds_read_b64 v[116:117], v11 offset:3264
    v_mfma_f32_16x16x32_bf16 v[156:159], v[16:19], v[56:59], v[156:159]
    ds_read_b64 v[118:119], v11 offset:3272
    v_mfma_f32_16x16x32_bf16 v[160:163], v[20:23], v[56:59], v[160:163]
    ds_read_b128 v[84:87], v10 offset:704
    v_mfma_f32_16x16x32_bf16 v[156:159], v[24:27], v[48:51], v[156:159]
    ds_read_b64 v[120:121], v11 offset:2752
    v_mfma_f32_16x16x32_bf16 v[160:163], v[24:27], v[52:55], v[160:163]
    ds_read_b64 v[122:123], v11 offset:2760
    v_mfma_f32_16x16x32_bf16 v[164:167], v[24:27], v[56:59], v[164:167]
    ds_read_b128 v[88:91], v10 offset:1216
    v_mfma_f32_16x16x32_bf16 v[160:163], v[16:19], v[60:63], v[160:163]
    ds_read_b64 v[124:125], v11 offset:2240
    v_mfma_f32_16x16x32_bf16 v[164:167], v[20:23], v[60:63], v[164:167]
    ds_read_b64 v[126:127], v11 offset:2248
    v_mfma_f32_16x16x32_bf16 v[168:171], v[24:27], v[60:63], v[168:171]
    ds_read_b128 v[92:95], v10 offset:1728
    v_mfma_f32_16x16x32_bf16 v[160:163], v[28:31], v[48:51], v[160:163]
    ds_read_b64 v[128:129], v11 offset:1728
    v_mfma_f32_16x16x32_bf16 v[164:167], v[28:31], v[52:55], v[164:167]
    ds_read_b64 v[130:131], v11 offset:1736
    v_mfma_f32_16x16x32_bf16 v[168:171], v[28:31], v[56:59], v[168:171]
    ds_read_b128 v[96:99], v10 offset:2240
    v_mfma_f32_16x16x32_bf16 v[172:175], v[28:31], v[60:63], v[172:175]
    ds_read_b64 v[132:133], v11 offset:1216
    v_mfma_f32_16x16x32_bf16 v[164:167], v[16:19], v[64:67], v[164:167]
    ds_read_b64 v[134:135], v11 offset:1224
    v_mfma_f32_16x16x32_bf16 v[168:171], v[20:23], v[64:67], v[168:171]
    ds_read_b128 v[100:103], v10 offset:2752
    v_mfma_f32_16x16x32_bf16 v[172:175], v[24:27], v[64:67], v[172:175]
    ds_read_b64 v[136:137], v11 offset:704
    v_mfma_f32_16x16x32_bf16 v[176:179], v[28:31], v[64:67], v[176:179]
    ds_read_b64 v[138:139], v11 offset:712
    v_mfma_f32_16x16x32_bf16 v[164:167], v[32:35], v[48:51], v[164:167]
    ds_read_b128 v[104:107], v10 offset:3264
    v_mfma_f32_16x16x32_bf16 v[168:171], v[32:35], v[52:55], v[168:171]
    ds_read_b64 v[140:141], v11 offset:192
    v_mfma_f32_16x16x32_bf16 v[172:175], v[32:35], v[56:59], v[172:175]
    ds_read_b64 v[142:143], v11 offset:200
    v_mfma_f32_16x16x32_bf16 v[176:179], v[32:35], v[60:63], v[176:179]
    ds_read_b128 v[108:111], v10 offset:3776
    v_mfma_f32_16x16x32_bf16 v[168:171], v[16:19], v[68:71], v[168:171]
    v_mfma_f32_16x16x32_bf16 v[172:175], v[20:23], v[68:71], v[172:175]
    v_mfma_f32_16x16x32_bf16 v[176:179], v[24:27], v[68:71], v[176:179]
    v_mfma_f32_16x16x32_bf16 v[168:171], v[36:39], v[48:51], v[168:171]
    v_mfma_f32_16x16x32_bf16 v[172:175], v[36:39], v[52:55], v[172:175]
    v_mfma_f32_16x16x32_bf16 v[176:179], v[36:39], v[56:59], v[176:179]
    v_mfma_f32_16x16x32_bf16 v[172:175], v[16:19], v[72:75], v[172:175]
    v_mfma_f32_16x16x32_bf16 v[176:179], v[20:23], v[72:75], v[176:179]
    v_mfma_f32_16x16x32_bf16 v[172:175], v[40:43], v[48:51], v[172:175]
    v_mfma_f32_16x16x32_bf16 v[176:179], v[40:43], v[52:55], v[176:179]
    v_add_u32 v10, 128, v10
    v_add_u32 v11, 128, v11
    v_mfma_f32_16x16x32_bf16 v[176:179], v[16:19], v[76:79], v[176:179]
    s_add_u32 s53, s53, 1
    s_cmp_lt_u32 s53, 3
    v_mfma_f32_16x16x32_bf16 v[176:179], v[44:47], v[48:51], v[176:179]
    s_cbranch_scc1 L_cv_9
    v_lshlrev_b32 v12, 3, v2
    s_waitcnt lgkmcnt(0)
    v_mfma_f32_16x16x32_bf16 v[176:179], v[80:83], v[140:143], v[176:179]
    s_mov_b32 s8, s82
    s_and_b32 s9, s83, 0xffff
    v_mfma_f32_16x16x32_bf16 v[176:179], v[84:87], v[136:139], v[176:179]
    s_mov_b32 s10, 819200
    s_mov_b32 s11, 0x20000
    v_mfma_f32_16x16x32_bf16 v[176:179], v[88:91], v[132:135], v[176:179]
    s_mov_b32 s30, 0
    s_mov_b32 s31, 0
    v_mfma_f32_16x16x32_bf16 v[176:179], v[92:95], v[128:131], v[176:179]
    s_mov_b32 s32, 41984
    s_mov_b32 s34, 4294925312
    v_mfma_f32_16x16x32_bf16 v[176:179], v[96:99], v[124:127], v[176:179]
    s_mov_b32 s35, 20992
    v_lshrrev_b32 v4, 3, v2
    v_mfma_f32_16x16x32_bf16 v[176:179], v[100:103], v[120:123], v[176:179]
    v_and_b32 v3, 7, v2
    v_lshlrev_b32 v3, 4, v3
    v_mfma_f32_16x16x32_bf16 v[176:179], v[104:107], v[116:119], v[176:179]
    v_mul_u32_u24 v4, 4352, v4
    v_add_u32 v238, v4, v3
    v_mfma_f32_16x16x32_bf16 v[176:179], v[108:111], v[112:115], v[176:179]
    s_mul_i32 s22, s17, 10
    s_add_u32 s22, s22, s16
    v_mfma_f32_16x16x32_bf16 v[172:175], v[80:83], v[136:139], v[172:175]
    s_mul_i32 s22, s22, 34816
    s_lshl_b32 s23, s18, 7
    v_mfma_f32_16x16x32_bf16 v[172:175], v[84:87], v[132:135], v[172:175]
    s_add_u32 s22, s22, s23
    s_add_u32 s21, s22, 11534336
    v_mfma_f32_16x16x32_bf16 v[172:175], v[88:91], v[128:131], v[172:175]
    v_cvt_pk_bf16_f32 v176, v176, v177
    v_cvt_pk_bf16_f32 v177, v178, v179
    v_mfma_f32_16x16x32_bf16 v[172:175], v[92:95], v[124:127], v[172:175]
    buffer_store_dwordx2 v[176:177], v12, s[12:15], s27 offen offset:3584 sc1
    s_mul_i32 s22, s17, 2560
    v_mfma_f32_16x16x32_bf16 v[172:175], v[96:99], v[120:123], v[172:175]
    s_add_u32 s22, s22, 17956864
    v_min_u32 v3, 19, v2
    v_mfma_f32_16x16x32_bf16 v[172:175], v[100:103], v[116:119], v[172:175]
    v_lshl_add_u32 v239, v3, 7, s22
    v_bfe_u32 v3, v2, 3, 2
    v_mfma_f32_16x16x32_bf16 v[172:175], v[104:107], v[112:115], v[172:175]
    v_lshlrev_b32 v3, 6, v3
    v_and_b32 v4, 7, v2
    v_mfma_f32_16x16x32_bf16 v[168:171], v[80:83], v[132:135], v[168:171]
    s_lshl_b32 s22, s17, 3
    v_add3_u32 v3, v3, v4, s22
    v_mfma_f32_16x16x32_bf16 v[168:171], v[84:87], v[128:131], v[168:171]
    v_cmp_gt_u32 vcc, 32, v2
    v_lshlrev_b32 v3, 7, v3
    v_mfma_f32_16x16x32_bf16 v[168:171], v[88:91], v[124:127], v[168:171]
    v_cvt_pk_bf16_f32 v172, v172, v173
    v_cvt_pk_bf16_f32 v173, v174, v175
    v_mfma_f32_16x16x32_bf16 v[168:171], v[92:95], v[120:123], v[168:171]
    buffer_store_dwordx2 v[172:173], v12, s[12:15], s27 offen offset:3072 sc1
    v_add_u32 v3, 18022400, v3
    v_mfma_f32_16x16x32_bf16 v[168:171], v[96:99], v[116:119], v[168:171]
    v_cndmask_b32 v239, v3, v239, vcc
    v_mfma_f32_16x16x32_bf16 v[168:171], v[100:103], v[112:115], v[168:171]
    v_mfma_f32_16x16x32_bf16 v[164:167], v[80:83], v[128:131], v[164:167]
    v_mfma_f32_16x16x32_bf16 v[164:167], v[84:87], v[124:127], v[164:167]
    v_mfma_f32_16x16x32_bf16 v[164:167], v[88:91], v[120:123], v[164:167]
    v_mfma_f32_16x16x32_bf16 v[164:167], v[92:95], v[116:119], v[164:167]
    v_mfma_f32_16x16x32_bf16 v[164:167], v[96:99], v[112:115], v[164:167]
    v_mfma_f32_16x16x32_bf16 v[160:163], v[80:83], v[124:127], v[160:163]
    v_mfma_f32_16x16x32_bf16 v[160:163], v[84:87], v[120:123], v[160:163]
    v_mfma_f32_16x16x32_bf16 v[160:163], v[88:91], v[116:119], v[160:163]
    v_cvt_pk_bf16_f32 v168, v168, v169
    v_cvt_pk_bf16_f32 v169, v170, v171
    v_mfma_f32_16x16x32_bf16 v[160:163], v[92:95], v[112:115], v[160:163]
    buffer_store_dwordx2 v[168:169], v12, s[12:15], s27 offen offset:2560 sc1
    v_mfma_f32_16x16x32_bf16 v[156:159], v[80:83], v[120:123], v[156:159]
    v_cvt_pk_bf16_f32 v164, v164, v165
    v_cvt_pk_bf16_f32 v165, v166, v167
    v_mfma_f32_16x16x32_bf16 v[156:159], v[84:87], v[116:119], v[156:159]
    buffer_store_dwordx2 v[164:165], v12, s[12:15], s27 offen offset:2048 sc1
    v_mfma_f32_16x16x32_bf16 v[156:159], v[88:91], v[112:115], v[156:159]
    v_mfma_f32_16x16x32_bf16 v[152:155], v[80:83], v[116:119], v[152:155]
    v_cvt_pk_bf16_f32 v160, v160, v161
    v_cvt_pk_bf16_f32 v161, v162, v163
    v_mfma_f32_16x16x32_bf16 v[152:155], v[84:87], v[112:115], v[152:155]
    buffer_store_dwordx2 v[160:161], v12, s[12:15], s27 offen offset:1536 sc1
    v_mfma_f32_16x16x32_bf16 v[148:151], v[80:83], v[112:115], v[148:151]
    s_nop 2
    v_cvt_pk_bf16_f32 v156, v156, v157
    v_cvt_pk_bf16_f32 v157, v158, v159
    buffer_store_dwordx2 v[156:157], v12, s[12:15], s27 offen offset:1024 sc1
    s_nop 2
    v_cvt_pk_bf16_f32 v152, v152, v153
    v_cvt_pk_bf16_f32 v153, v154, v155
    buffer_store_dwordx2 v[152:153], v12, s[12:15], s27 offen offset:512 sc1
    v_cvt_pk_bf16_f32 v148, v148, v149
    v_cvt_pk_bf16_f32 v149, v150, v151
    buffer_store_dwordx2 v[148:149], v12, s[12:15], s27 offen offset:0 sc1
    s_branch L_attn2
L_g_kb:
    s_lshr_b64 s[58:59], s[58:59], 4
    s_add_u32 s99, s99, 32768
    s_lshr_b32 s22, s99, 15
    s_cmp_eq_u32 s22, 3
    s_cselect_b32 s22, 32768, 0
    s_add_u32 s99, s99, s22
    s_cmp_ge_u32 s99, 163840
    s_cselect_b32 s22, 163840, 0
    s_sub_u32 s99, s99, s22
    s_lshr_b64 s[58:59], s[58:59], 4
    s_add_u32 s99, s99, 32768
    s_lshr_b32 s22, s99, 15
    s_cmp_eq_u32 s22, 3
    s_cselect_b32 s22, 32768, 0
    s_add_u32 s99, s99, s22
    s_cmp_ge_u32 s99, 163840
    s_cselect_b32 s22, 163840, 0
    s_sub_u32 s99, s99, s22
    s_and_b32 s43, s58, 15
    s_lshr_b64 s[58:59], s[58:59], 4
    s_lshl_b32 s100, s43, 7
    s_add_u32 s100, s100, s56
    s_mul_i32 s101, s43, 245760
    s_add_u32 s101, s101, s57
    s_add_u32 m0, s99, 0
    s_nop 0
    buffer_load_dwordx4 v240, s[60:63], s100 offen  lds
    s_add_u32 m0, s99, 16384
    s_nop 0
    buffer_load_dwordx4 v244, s[8:11], s101 offen  lds
    s_add_u32 m0, s99, 4096
    s_nop 0
    buffer_load_dwordx4 v241, s[60:63], s100 offen  lds
    s_add_u32 m0, s99, 20480
    s_nop 0
    buffer_load_dwordx4 v245, s[8:11], s101 offen  lds
    s_add_u32 m0, s99, 8192
    s_nop 0
    buffer_load_dwordx4 v242, s[60:63], s100 offen  lds
    s_add_u32 m0, s99, 24576
    s_nop 0
    buffer_load_dwordx4 v246, s[8:11], s101 offen  lds
    s_add_u32 m0, s99, 12288
    s_nop 0
    buffer_load_dwordx4 v243, s[60:63], s100 offen  lds
    s_add_u32 m0, s99, 28672
    s_nop 0
    buffer_load_dwordx4 v247, s[8:11], s101 offen  lds
    s_add_u32 s99, s99, 32768
    s_lshr_b32 s43, s99, 15
    s_cmp_eq_u32 s43, 3
    s_cselect_b32 s43, 32768, 0
    s_add_u32 s99, s99, s43
    s_cmp_ge_u32 s99, 163840
    s_cselect_b32 s43, 163840, 0
    s_sub_u32 s99, s99, s43
    s_setprio 2
    v_add_u32 v6, s28, v224
    ds_write_b128 v6, v[192:195] offset:0
    ds_write_b128 v6, v[196:199] offset:1024
    ds_write_b128 v6, v[200:203] offset:2048
    ds_write_b128 v6, v[204:207] offset:3072
L_gemm:
    s_and_b32 s34, s16, 1
    s_lshr_b32 s35, s16, 1
    v_and_b32 v3, 31, v2
    v_lshrrev_b32 v4, 5, v2
    v_bfe_u32 v5, v3, 1, 3
    v_xor_b32 v5, v5, v4
    v_lshlrev_b32 v5, 4, v5
    v_lshlrev_b32 v6, 7, v3
    s_lshl_b32 s22, s34, 13
    v_add3_u32 v10, v5, v6, s22
    v_xor_b32 v11, 32, v10
    v_xor_b32 v12, 64, v10
    v_xor_b32 v13, 96, v10
    v_bfe_u32 v5, v2, 2, 2
    s_lshl_b32 s22, s35, 1
    v_xor_b32 v6, s22, v5
    v_lshlrev_b32 v6, 6, v6
    v_lshlrev_b32 v7, 3, v4
    v_add_u32 v7, v7, v5
    v_lshlrev_b32 v7, 8, v7
    v_bfe_u32 v5, v2, 4, 1
    v_lshlrev_b32 v5, 5, v5
    v_add3_u32 v6, v6, v7, v5
    v_and_b32 v5, 3, v2
    v_lshl_add_u32 v6, v5, 3, v6
    v_add_u32 v14, 16384, v6
    v_xor_b32 v15, 64, v14
    v_lshlrev_b32 v5, 10, v4
    v_lshl_add_u32 v5, v3, 4, v5
    s_lshl_b32 s26, s21, 5
    s_lshl_b32 s23, s35, 4
    s_add_u32 s26, s26, s23
    s_lshl_b32 s26, s26, 10
    s_mul_i32 s23, s20, 491520
    s_add_u32 s26, s26, s23
    s_lshl_b32 s23, s34, 9
    s_add_u32 s26, s26, s23
    v_mov_b64 v[16:17], 0
    v_mov_b64 v[18:19], 0
    s_nop 1
    v_mfma_f32_32x32x16_bf16 v[48:63], v[16:19], v[16:19], 0
    v_mfma_f32_32x32x16_bf16 v[64:79], v[16:19], v[16:19], 0
    v_mfma_f32_32x32x16_bf16 v[80:95], v[16:19], v[16:19], 0
    v_mfma_f32_32x32x16_bf16 v[96:111], v[16:19], v[16:19], 0
    s_cmp_lt_u32 s18, 20
    s_cbranch_scc1 L_g_w
    s_barrier
    s_and_b32 s43, s58, 15
    s_lshr_b64 s[58:59], s[58:59], 4
    s_lshl_b32 s100, s43, 7
    s_add_u32 s100, s100, s56
    s_mul_i32 s101, s43, 245760
    s_add_u32 s101, s101, s57
    s_add_u32 m0, s99, 0
    s_nop 0
    buffer_load_dwordx4 v240, s[60:63], s100 offen  lds
    s_add_u32 m0, s99, 16384
    s_nop 0
    buffer_load_dwordx4 v244, s[8:11], s101 offen  lds
    s_add_u32 m0, s99, 4096
    s_nop 0
    buffer_load_dwordx4 v241, s[60:63], s100 offen  lds
    s_add_u32 m0, s99, 20480
    s_nop 0
    buffer_load_dwordx4 v245, s[8:11], s101 offen  lds
    s_add_u32 m0, s99, 8192
    s_nop 0
    buffer_load_dwordx4 v242, s[60:63], s100 offen  lds
    s_add_u32 m0, s99, 24576
    s_nop 0
    buffer_load_dwordx4 v246, s[8:11], s101 offen  lds
    s_add_u32 m0, s99, 12288
    s_nop 0
    buffer_load_dwordx4 v243, s[60:63], s100 offen  lds
    s_add_u32 m0, s99, 28672
    s_nop 0
    buffer_load_dwordx4 v247, s[8:11], s101 offen  lds
    s_add_u32 s99, s99, 32768
    s_lshr_b32 s43, s99, 15
    s_cmp_eq_u32 s43, 3
    s_cselect_b32 s43, 32768, 0
    s_add_u32 s99, s99, s43
    s_cmp_ge_u32 s99, 163840
    s_cselect_b32 s43, 163840, 0
    s_sub_u32 s99, s99, s43
L_g_w:
    s_and_b32 s43, s58, 15
    s_lshr_b64 s[58:59], s[58:59], 4
    s_lshl_b32 s100, s43, 7
    s_add_u32 s100, s100, s56
    s_mul_i32 s101, s43, 245760
    s_add_u32 s101, s101, s57
    s_add_u32 m0, s99, 0
    s_nop 0
    buffer_load_dwordx4 v240, s[60:63], s100 offen  lds
    s_add_u32 m0, s99, 16384
    s_nop 0
    buffer_load_dwordx4 v244, s[8:11], s101 offen  lds
    s_add_u32 m0, s99, 4096
    s_nop 0
    buffer_load_dwordx4 v241, s[60:63], s100 offen  lds
    s_add_u32 m0, s99, 20480
    s_nop 0
    buffer_load_dwordx4 v245, s[8:11], s101 offen  lds
    s_add_u32 m0, s99, 8192
    s_nop 0
    buffer_load_dwordx4 v242, s[60:63], s100 offen  lds
    s_add_u32 m0, s99, 24576
    s_nop 0
    buffer_load_dwordx4 v246, s[8:11], s101 offen  lds
    s_add_u32 m0, s99, 12288
    s_nop 0
    buffer_load_dwordx4 v243, s[60:63], s100 offen  lds
    s_add_u32 m0, s99, 28672
    s_nop 0
    buffer_load_dwordx4 v247, s[8:11], s101 offen  lds
    s_add_u32 s99, s99, 32768
    s_lshr_b32 s43, s99, 15
    s_cmp_eq_u32 s43, 3
    s_cselect_b32 s43, 32768, 0
    s_add_u32 s99, s99, s43
    s_cmp_ge_u32 s99, 163840
    s_cselect_b32 s43, 163840, 0
    s_sub_u32 s99, s99, s43
    s_waitcnt vmcnt(16) lgkmcnt(0)
    s_cmp_lt_u32 s18, 20
    s_cselect_b32 s27, 2, 1
    s_mov_b32 s30, 0
    s_mov_b32 s31, 0
    s_setprio 2
    s_barrier
    ds_read_b128 v[16:19], v10 offset:0
    ds_read_b64_tr_b16 v[24:25], v14 offset:0
    ds_read_b64_tr_b16 v[26:27], v14 offset:1024
    ds_read_b128 v[20:23], v10 offset:4096
    ds_read_b64_tr_b16 v[28:29], v15 offset:0
    ds_read_b64_tr_b16 v[30:31], v15 offset:1024
.p2align 3
L_g_mm:
    s_waitcnt lgkmcnt(3)
    v_mfma_f32_32x32x16_bf16 v[48:63], v[24:27], v[16:19], v[48:63]
    ds_read_b128 v[32:35], v11 offset:0
    ds_read_b64_tr_b16 v[40:41], v14 offset:4096
    ds_read_b64_tr_b16 v[42:43], v14 offset:5120
    s_waitcnt lgkmcnt(5)
    v_mfma_f32_32x32x16_bf16 v[64:79], v[24:27], v[20:23], v[64:79]
    ds_read_b128 v[36:39], v11 offset:4096
    ds_read_b64_tr_b16 v[44:45], v15 offset:4096
    ds_read_b64_tr_b16 v[46:47], v15 offset:5120
    s_waitcnt lgkmcnt(6)
    v_mfma_f32_32x32x16_bf16 v[80:95], v[28:31], v[16:19], v[80:95]
    s_mov_b32 s32, s31
    s_add_u32 s31, s31, 32768
    s_lshr_b32 s33, s31, 15
    s_cmp_eq_u32 s33, 3
    s_cselect_b32 s33, 32768, 0
    s_add_u32 s31, s31, s33
    s_cmp_ge_u32 s31, 163840
    s_cselect_b32 s33, 163840, 0
    s_sub_u32 s31, s31, s33
    v_mfma_f32_32x32x16_bf16 v[96:111], v[28:31], v[20:23], v[96:111]
    s_waitcnt lgkmcnt(3)
    v_mfma_f32_32x32x16_bf16 v[48:63], v[40:43], v[32:35], v[48:63]
    ds_read_b128 v[16:19], v12 offset:0
    ds_read_b64_tr_b16 v[24:25], v14 offset:8192
    ds_read_b64_tr_b16 v[26:27], v14 offset:9216
    s_waitcnt lgkmcnt(5)
    v_mfma_f32_32x32x16_bf16 v[64:79], v[40:43], v[36:39], v[64:79]
    ds_read_b128 v[20:23], v12 offset:4096
    ds_read_b64_tr_b16 v[28:29], v15 offset:8192
    ds_read_b64_tr_b16 v[30:31], v15 offset:9216
    s_waitcnt lgkmcnt(6)
    v_mfma_f32_32x32x16_bf16 v[80:95], v[44:47], v[32:35], v[80:95]
    s_sub_u32 s33, s31, s32
    s_add_u32 s30, s30, 1
    v_add_u32 v10, s33, v10
    v_add_u32 v11, s33, v11
    v_add_u32 v12, s33, v12
    v_mfma_f32_32x32x16_bf16 v[96:111], v[44:47], v[36:39], v[96:111]
    s_waitcnt lgkmcnt(3)
    v_mfma_f32_32x32x16_bf16 v[48:63], v[24:27], v[16:19], v[48:63]
    ds_read_b128 v[32:35], v13 offset:0
    ds_read_b64_tr_b16 v[40:41], v14 offset:12288
    ds_read_b64_tr_b16 v[42:43], v14 offset:13312
    s_waitcnt lgkmcnt(5)
    v_mfma_f32_32x32x16_bf16 v[64:79], v[24:27], v[20:23], v[64:79]
    ds_read_b128 v[36:39], v13 offset:4096
    ds_read_b64_tr_b16 v[44:45], v15 offset:12288
    ds_read_b64_tr_b16 v[46:47], v15 offset:13312
    s_waitcnt lgkmcnt(6)
    v_mfma_f32_32x32x16_bf16 v[80:95], v[28:31], v[16:19], v[80:95]
    v_add_u32 v13, s33, v13
    v_add_u32 v14, s33, v14
    v_add_u32 v15, s33, v15
    s_cmp_le_u32 s30, s27
    v_mfma_f32_32x32x16_bf16 v[96:111], v[28:31], v[20:23], v[96:111]
    s_waitcnt lgkmcnt(3)
    v_mfma_f32_32x32x16_bf16 v[48:63], v[40:43], v[32:35], v[48:63]
    s_cbranch_scc1 L_g_w8
    s_waitcnt vmcnt(0)
L_g_w8:
    s_waitcnt vmcnt(8) lgkmcnt(0)
    s_cmp_gt_u32 s30, 8
    s_cbranch_scc1 L_g_nb
    s_barrier
L_g_nb:
    v_mfma_f32_32x32x16_bf16 v[64:79], v[40:43], v[36:39], v[64:79]
    ds_read_b128 v[16:19], v10 offset:0
    ds_read_b64_tr_b16 v[24:25], v14 offset:0
    ds_read_b64_tr_b16 v[26:27], v14 offset:1024
    s_cmp_lt_u32 s30, 10
    v_mfma_f32_32x32x16_bf16 v[80:95], v[44:47], v[32:35], v[80:95]
    ds_read_b128 v[20:23], v10 offset:4096
    ds_read_b64_tr_b16 v[28:29], v15 offset:0
    ds_read_b64_tr_b16 v[30:31], v15 offset:1024
    v_mfma_f32_32x32x16_bf16 v[96:111], v[44:47], v[36:39], v[96:111]
    s_cbranch_scc1 L_g_mm
    s_nop 4
    s_waitcnt lgkmcnt(0)
    s_cmp_lt_u32 s21, 5
    s_cbranch_scc1 L_g_eq
    v_cvt_pk_bf16_f32 v16, v48, v49
    v_cvt_pk_bf16_f32 v17, v50, v51
    v_cvt_pk_bf16_f32 v18, v64, v65
    v_cvt_pk_bf16_f32 v19, v66, v67
    s_add_u32 s23, s26, 0
    buffer_store_dwordx4 v[16:19], v5, s[12:15], s23 offen offset:0 sc1
    v_cvt_pk_bf16_f32 v20, v52, v53
    v_cvt_pk_bf16_f32 v21, v54, v55
    v_cvt_pk_bf16_f32 v22, v68, v69
    v_cvt_pk_bf16_f32 v23, v70, v71
    buffer_store_dwordx4 v[20:23], v5, s[12:15], s23 offen offset:2048 sc1
    v_cvt_pk_bf16_f32 v24, v56, v57
    v_cvt_pk_bf16_f32 v25, v58, v59
    v_cvt_pk_bf16_f32 v26, v72, v73
    v_cvt_pk_bf16_f32 v27, v74, v75
    s_add_u32 s23, s26, 4096
    buffer_store_dwordx4 v[24:27], v5, s[12:15], s23 offen offset:0 sc1
    v_cvt_pk_bf16_f32 v28, v60, v61
    v_cvt_pk_bf16_f32 v29, v62, v63
    v_cvt_pk_bf16_f32 v30, v76, v77
    v_cvt_pk_bf16_f32 v31, v78, v79
    buffer_store_dwordx4 v[28:31], v5, s[12:15], s23 offen offset:2048 sc1
    v_cvt_pk_bf16_f32 v32, v80, v81
    v_cvt_pk_bf16_f32 v33, v82, v83
    v_cvt_pk_bf16_f32 v34, v96, v97
    v_cvt_pk_bf16_f32 v35, v98, v99
    s_add_u32 s23, s26, 8192
    buffer_store_dwordx4 v[32:35], v5, s[12:15], s23 offen offset:0 sc1
    v_cvt_pk_bf16_f32 v36, v84, v85
    v_cvt_pk_bf16_f32 v37, v86, v87
    v_cvt_pk_bf16_f32 v38, v100, v101
    v_cvt_pk_bf16_f32 v39, v102, v103
    buffer_store_dwordx4 v[36:39], v5, s[12:15], s23 offen offset:2048 sc1
    v_cvt_pk_bf16_f32 v40, v88, v89
    v_cvt_pk_bf16_f32 v41, v90, v91
    v_cvt_pk_bf16_f32 v42, v104, v105
    v_cvt_pk_bf16_f32 v43, v106, v107
    s_add_u32 s23, s26, 12288
    buffer_store_dwordx4 v[40:43], v5, s[12:15], s23 offen offset:0 sc1
    v_cvt_pk_bf16_f32 v44, v92, v93
    v_cvt_pk_bf16_f32 v45, v94, v95
    v_cvt_pk_bf16_f32 v46, v108, v109
    v_cvt_pk_bf16_f32 v47, v110, v111
    buffer_store_dwordx4 v[44:47], v5, s[12:15], s23 offen offset:2048 sc1
    s_branch L_w1
L_g_eq:
    s_mov_b32 s28, 0x3ea52b5c
    v_mul_f32 v48, s28, v48
    v_mul_f32 v49, s28, v49
    v_mul_f32 v50, s28, v50
    v_mul_f32 v51, s28, v51
    v_cvt_pk_bf16_f32 v16, v48, v49
    v_cvt_pk_bf16_f32 v17, v50, v51
    v_mul_f32 v64, s28, v64
    v_mul_f32 v65, s28, v65
    v_mul_f32 v66, s28, v66
    v_mul_f32 v67, s28, v67
    v_cvt_pk_bf16_f32 v18, v64, v65
    v_cvt_pk_bf16_f32 v19, v66, v67
    s_add_u32 s23, s26, 0
    buffer_store_dwordx4 v[16:19], v5, s[12:15], s23 offen offset:0 sc1
    v_mul_f32 v52, s28, v52
    v_mul_f32 v53, s28, v53
    v_mul_f32 v54, s28, v54
    v_mul_f32 v55, s28, v55
    v_cvt_pk_bf16_f32 v20, v52, v53
    v_cvt_pk_bf16_f32 v21, v54, v55
    v_mul_f32 v68, s28, v68
    v_mul_f32 v69, s28, v69
    v_mul_f32 v70, s28, v70
    v_mul_f32 v71, s28, v71
    v_cvt_pk_bf16_f32 v22, v68, v69
    v_cvt_pk_bf16_f32 v23, v70, v71
    buffer_store_dwordx4 v[20:23], v5, s[12:15], s23 offen offset:2048 sc1
    v_mul_f32 v56, s28, v56
    v_mul_f32 v57, s28, v57
    v_mul_f32 v58, s28, v58
    v_mul_f32 v59, s28, v59
    v_cvt_pk_bf16_f32 v24, v56, v57
    v_cvt_pk_bf16_f32 v25, v58, v59
    v_mul_f32 v72, s28, v72
    v_mul_f32 v73, s28, v73
    v_mul_f32 v74, s28, v74
    v_mul_f32 v75, s28, v75
    v_cvt_pk_bf16_f32 v26, v72, v73
    v_cvt_pk_bf16_f32 v27, v74, v75
    s_add_u32 s23, s26, 4096
    buffer_store_dwordx4 v[24:27], v5, s[12:15], s23 offen offset:0 sc1
    v_mul_f32 v60, s28, v60
    v_mul_f32 v61, s28, v61
    v_mul_f32 v62, s28, v62
    v_mul_f32 v63, s28, v63
    v_cvt_pk_bf16_f32 v28, v60, v61
    v_cvt_pk_bf16_f32 v29, v62, v63
    v_mul_f32 v76, s28, v76
    v_mul_f32 v77, s28, v77
    v_mul_f32 v78, s28, v78
    v_mul_f32 v79, s28, v79
    v_cvt_pk_bf16_f32 v30, v76, v77
    v_cvt_pk_bf16_f32 v31, v78, v79
    buffer_store_dwordx4 v[28:31], v5, s[12:15], s23 offen offset:2048 sc1
    v_mul_f32 v80, s28, v80
    v_mul_f32 v81, s28, v81
    v_mul_f32 v82, s28, v82
    v_mul_f32 v83, s28, v83
    v_cvt_pk_bf16_f32 v32, v80, v81
    v_cvt_pk_bf16_f32 v33, v82, v83
    v_mul_f32 v96, s28, v96
    v_mul_f32 v97, s28, v97
    v_mul_f32 v98, s28, v98
    v_mul_f32 v99, s28, v99
    v_cvt_pk_bf16_f32 v34, v96, v97
    v_cvt_pk_bf16_f32 v35, v98, v99
    s_add_u32 s23, s26, 8192
    buffer_store_dwordx4 v[32:35], v5, s[12:15], s23 offen offset:0 sc1
    v_mul_f32 v84, s28, v84
    v_mul_f32 v85, s28, v85
    v_mul_f32 v86, s28, v86
    v_mul_f32 v87, s28, v87
    v_cvt_pk_bf16_f32 v36, v84, v85
    v_cvt_pk_bf16_f32 v37, v86, v87
    v_mul_f32 v100, s28, v100
    v_mul_f32 v101, s28, v101
    v_mul_f32 v102, s28, v102
    v_mul_f32 v103, s28, v103
    v_cvt_pk_bf16_f32 v38, v100, v101
    v_cvt_pk_bf16_f32 v39, v102, v103
    buffer_store_dwordx4 v[36:39], v5, s[12:15], s23 offen offset:2048 sc1
    v_mul_f32 v88, s28, v88
    v_mul_f32 v89, s28, v89
    v_mul_f32 v90, s28, v90
    v_mul_f32 v91, s28, v91
    v_cvt_pk_bf16_f32 v40, v88, v89
    v_cvt_pk_bf16_f32 v41, v90, v91
    v_mul_f32 v104, s28, v104
    v_mul_f32 v105, s28, v105
    v_mul_f32 v106, s28, v106
    v_mul_f32 v107, s28, v107
    v_cvt_pk_bf16_f32 v42, v104, v105
    v_cvt_pk_bf16_f32 v43, v106, v107
    s_add_u32 s23, s26, 12288
    buffer_store_dwordx4 v[40:43], v5, s[12:15], s23 offen offset:0 sc1
    v_mul_f32 v92, s28, v92
    v_mul_f32 v93, s28, v93
    v_mul_f32 v94, s28, v94
    v_mul_f32 v95, s28, v95
    v_cvt_pk_bf16_f32 v44, v92, v93
    v_cvt_pk_bf16_f32 v45, v94, v95
    v_mul_f32 v108, s28, v108
    v_mul_f32 v109, s28, v109
    v_mul_f32 v110, s28, v110
    v_mul_f32 v111, s28, v111
    v_cvt_pk_bf16_f32 v46, v108, v109
    v_cvt_pk_bf16_f32 v47, v110, v111
    buffer_store_dwordx4 v[44:47], v5, s[12:15], s23 offen offset:2048 sc1
L_w1:
    s_load_dword s19, s[86:87], 0
    s_mov_b32 s50, 0
    v_mov_b32 v222, 0
    s_waitcnt lgkmcnt(0)
L_nonce_10:
    s_cmp_lg_u32 s19, 0
    s_cbranch_scc1 L_nonce_e_11
    global_load_dword v223, v222, s[86:87] sc1
    s_add_u32 s50, s50, 1
    s_waitcnt vmcnt(0)
    v_readfirstlane_b32 s19, v223
    s_cmp_lt_u32 s50, 262144
    s_cbranch_scc1 L_nonce_10
L_nonce_e_11:
    v_mov_b32 v3, 129536
    v_mov_b32 v4, 1
    s_lshl_b32 s22, s2, 7
    s_add_u32 s26, s22, 17891328
    s_mov_b32 s8, s82
    s_and_b32 s9, s83, 0xffff
    s_mov_b32 s10, 819200
    s_mov_b32 s11, 0x20000
    s_mov_b32 s30, 0
    s_mov_b32 s31, 0
    s_mov_b32 s32, 41984
    s_mov_b32 s34, 4294925312
    s_mov_b32 s35, 20992
    v_mov_b64 v[104:105], 0
    v_mov_b64 v[106:107], 0
    v_mov_b64 v[108:109], 0
    v_mov_b64 v[110:111], 0
    v_mov_b64 v[112:113], 0
    v_mov_b64 v[114:115], 0
    v_mov_b64 v[116:117], 0
    v_mov_b64 v[118:119], 0
    v_mov_b64 v[120:121], 0
    v_mov_b64 v[122:123], 0
    v_mov_b64 v[124:125], 0
    v_mov_b64 v[126:127], 0
    v_mov_b64 v[128:129], 0
    v_mov_b64 v[130:131], 0
    v_mov_b64 v[132:133], 0
    v_mov_b64 v[134:135], 0
    v_mov_b64 v[64:65], 0
    v_mov_b64 v[48:49], 0
    v_mov_b64 v[66:67], 0
    v_mov_b64 v[50:51], 0
    v_mov_b64 v[68:69], 0
    v_mov_b64 v[52:53], 0
    v_mov_b64 v[70:71], 0
    v_mov_b64 v[54:55], 0
    s_waitcnt vmcnt(0)
    s_mov_b64 exec, 1
    ds_add_rtn_u32 v4, v3, v4
    s_mov_b64 exec, -1
    s_waitcnt lgkmcnt(0)
    v_readfirstlane_b32 s22, v4
    s_mov_b32 s28, s22
    s_mov_b32 s33, 0
    s_cmp_lg_u32 s22, 3
    s_cbranch_scc1 L_w1_r
    v_mov_b32 v6, 0
    v_mov_b32 v7, s19
    s_mov_b64 exec, 1
    buffer_store_dword v7, v6, s[12:15], s26 offen sc1
    s_mov_b64 exec, -1
    v_mov_b32 v16, 0x3f803f80
    v_mov_b32 v17, 0x00003f80
    v_mov_b32 v18, 0x3f803f80
    v_mov_b32 v19, 0x00003f80
    ds_write_b128 v224, v[16:19] offset:64
    ds_write_b32 v6, v6 offset:0
    s_mov_b32 s33, 1
    s_branch L_setup
L_w1_r:
    s_setprio 0
L_setup:
    s_lshl_b32 s37, s17, 2
    s_lshr_b32 s22, s18, 3
    s_add_u32 s37, s37, s22
    s_and_b32 s38, s18, 7
    s_mul_i32 s22, s38, 327680
    s_add_u32 s22, s22, 8388608
    s_lshl_b32 s54, s37, 9
    s_add_u32 s54, s54, s22
    s_lshl_b32 s55, s37, 7
    s_add_u32 s55, s55, s22
    s_add_u32 s55, s55, 16384
    s_mul_i32 s37, s37, 5
    s_lshl_b32 s39, s37, 10
    s_mul_i32 s22, s38, 983040
    s_add_u32 s39, s39, s22
    v_and_b32 v3, 15, v2
    v_bfe_u32 v4, v2, 4, 1
    v_mul_u32_u24 v4, 20480, v4
    v_lshl_add_u32 v237, v3, 3, v4
    v_lshl_add_u32 v4, v3, 4, v4
    v_lshrrev_b32 v3, 5, v2
    v_lshl_add_u32 v236, v3, 8, v4
    s_lshr_b32 s22, s16, 1
    s_and_b32 s23, s16, 1
    s_mul_i32 s44, s22, 2080
    s_lshl_b32 s24, s23, 10
    s_add_u32 s44, s44, s24
    s_add_u32 s44, s44, 1280
    s_add_u32 s45, s44, 8320
    s_add_u32 s46, s44, 16640
    s_add_u32 s24, s22, s37
    s_lshl_b32 s24, s24, 10
    s_mul_i32 s23, s23, 3932160
    s_add_u32 s24, s24, s23
    s_add_u32 s40, s24, 655360
    s_add_u32 s42, s24, 822272
    s_cmp_eq_u32 s22, 0
    s_cselect_b32 s23, 0, 158720
    s_add_u32 s41, s40, s23
    s_add_u32 s41, s41, 4096
    v_and_b32 v3, 31, v2
    v_lshlrev_b32 v3, 3, v3
    v_lshrrev_b32 v5, 5, v2
    s_lshl_b32 s49, s48, 10
    s_lshl_b32 s22, s51, 1
    s_add_u32 s22, s22, s48
    s_lshl_b32 s22, s22, 8
    v_add_u32 v231, s22, v3
    v_lshl_add_u32 v232, v5, 12, v231
    v_mul_u32_u24 v225, 4160, v5
    s_add_u32 s22, s49, 1280
    v_add3_u32 v225, v225, v3, s22
    v_xor_b32 v229, 1, v5
    s_add_u32 s22, s22, 8256
    v_mad_u32_u24 v226, v229, s22, v3
    v_add_u32 v226, 64, v226
    v_bfe_u32 v3, v2, 2, 2
    v_lshl_add_u32 v5, v5, 2, v3
    v_and_b32 v4, 3, v2
    v_bfe_u32 v3, v2, 4, 1
    v_lshl_add_u32 v4, v3, 2, v4
    v_cmp_gt_u32 vcc, 5, v4
    v_mul_u32_u24 v4, 2080, v4
    s_add_u32 s22, s49, 11680
    v_add_u32 v4, s22, v4
    v_cndmask_b32 v227, 64, v4, vcc
    v_cndmask_b32 v228, 0, 1, vcc
    v_lshl_add_u32 v227, v5, 3, v227
    s_sub_u32 s24, 106, s16
    s_mul_i32 s94, s24, 7680
    s_lshr_b32 s22, s18, 2
    s_mul_i32 s22, s22, 160
    s_add_u32 s94, s94, s22
    s_mul_i32 s95, s24, 960
    s_add_u32 s95, s95, 61056
    v_mul_u32_u24 v6, 205, v2
    v_lshrrev_b32 v6, 11, v6
    v_mul_u32_u24 v7, 10, v6
    v_sub_u32 v7, v2, v7
    v_lshlrev_b32 v7, 4, v7
    v_mul_u32_u24 v6, 1280, v6
    v_add_u32 v230, v6, v7
    v_add_u32 v250, v6, v230
    v_bfe_u32 v3, v2, 2, 2
    v_lshrrev_b32 v4, 4, v2
    v_and_b32 v5, 3, v2
    v_lshlrev_b32 v5, 3, v5
    v_lshrrev_b32 v6, 2, v2
    v_lshl_add_u32 v6, v6, 7, v5
    s_lshl_b32 s22, s51, 5
    v_add_u32 v253, s22, v6
    v_lshrrev_b32 v6, 5, v2
    v_mul_u32_u24 v6, 12, v6
    v_lshl_add_u32 v6, v4, 2, v6
    v_add_u32 v6, v6, v3
    v_mad_u32_u24 v7, v4, 20, v3
    s_mul_i32 s22, s48, 51200
    s_add_u32 s22, s22, 61056
    v_add_u32 v5, s22, v5
    s_movk_i32 s23, 160
    v_mad_u32_u24 v248, v6, s23, v5
    v_mad_u32_u24 v249, v7, s23, v5
    v_and_b32 v3, 15, v2
    s_mul_i32 s22, s51, 5120
    v_lshl_add_u32 v4, v4, 3, s22
    v_mad_u32_u24 v251, v3, s23, v4
    s_lshl_b32 s24, s17, 2
    s_and_b32 s22, s18, 3
    s_add_u32 s24, s24, s22
    s_lshl_b32 s24, s24, 2
    s_add_u32 s24, s24, s51
    s_mul_i32 s96, s24, 20480
    s_add_u32 s96, s96, 8388608
    s_lshl_b32 s23, s48, 11
    s_add_u32 s97, s96, s23
    s_add_u32 s97, s97, 16384
    s_lshl_b32 s23, s48, 13
    s_add_u32 s96, s96, s23
    s_lshr_b32 s22, s18, 2
    s_add_u32 s22, s22, 8
    s_lshl_b32 s23, s18, 2
    s_add_u32 s23, s23, s51
    s_cmp_eq_u32 s48, 0
    s_cselect_b32 s24, s23, s24
    s_cselect_b32 s22, s17, s22
    s_mul_i32 s98, s24, 40960
    s_mul_i32 s22, s22, 160
    s_add_u32 s98, s98, s22
    v_lshrrev_b32 v4, 3, v2
    v_and_b32 v3, 7, v2
    v_lshlrev_b32 v3, 4, v3
    v_mul_u32_u24 v4, 4352, v4
    v_add_u32 v238, v4, v3
    s_mul_i32 s22, s17, 10
    s_add_u32 s22, s22, s16
    s_mul_i32 s22, s22, 34816
    s_lshl_b32 s23, s18, 7
    s_add_u32 s22, s22, s23
    s_add_u32 s21, s22, 11534336
    s_mul_i32 s22, s17, 2560
    s_add_u32 s22, s22, 17956864
    v_min_u32 v3, 19, v2
    v_lshl_add_u32 v239, v3, 7, s22
    v_bfe_u32 v3, v2, 3, 2
    v_lshlrev_b32 v3, 6, v3
    v_and_b32 v4, 7, v2
    s_lshl_b32 s22, s17, 3
    v_add3_u32 v3, v3, v4, s22
    v_cmp_gt_u32 vcc, 32, v2
    v_lshlrev_b32 v3, 7, v3
    v_add_u32 v3, 18022400, v3
    v_cndmask_b32 v239, v3, v239, vcc
    s_cmp_eq_u32 s33, 2
    s_cbranch_scc1 L_attn
    s_lshl_b32 s22, s2, 7
    s_lshl_b32 s23, s28, 2
    s_add_u32 s22, s22, s23
    s_add_u32 s36, s22, 18022400
    s_cmp_eq_u32 s33, 1
    s_cbranch_scc1 L_w1_po
L_w1_c:
    v_lshrrev_b32 v140, 5, v2
    v_mul_u32_u24 v140, 40960, v140
    v_add_u32 v140, v140, v237
    v_mov_b32 v136, -1
    v_mov_b32 v137, -1
    v_mov_b32 v138, -1
    v_mov_b32 v139, -1
    s_mul_i32 s24, s28, 81920
    s_add_u32 s22, s24, s54
    s_add_u32 s23, s22, 40960
    s_add_u32 s24, s24, s55
    buffer_store_dwordx4 v[136:139], v236, s[12:15], s22 offen sc1
    buffer_store_dwordx4 v[136:139], v236, s[12:15], s23 offen sc1
    buffer_store_dwordx2 v[136:137], v140, s[12:15], s24 offen sc1
    s_cmp_lg_u32 s28, 0
    s_cbranch_scc1 L_at_b2
    s_mov_b32 s28, 3
    s_branch L_w1_c
L_w1_po:
    v_and_b32 v3, 15, v2
    v_lshrrev_b32 v4, 5, v2
    v_mul_u32_u24 v4, 160, v4
    v_bfe_u32 v5, v2, 4, 1
    v_lshl_add_u32 v4, v5, 2, v4
    s_add_u32 s22, s37, 160
    v_add_u32 v4, s22, v4
    v_lshrrev_b32 v4, 5, v4
    v_cmp_eq_u32 vcc, 7, v4
    v_bfe_u32 v10, v3, 1, 1
    v_lshrrev_b32 v11, 3, v4
    v_cndmask_b32 v10, v11, v10, vcc
    v_and_b32 v11, 3, v3
    v_and_b32 v12, 1, v3
    v_cndmask_b32 v11, v11, v12, vcc
    v_and_b32 v12, 7, v4
    v_lshl_add_u32 v11, v12, 2, v11
    v_lshl_add_u32 v10, v11, 3, v10
    v_lshrrev_b32 v11, 2, v3
    v_lshl_add_u32 v8, v11, 1, v10
    v_lshlrev_b32 v8, 7, v8
    v_add_u32 v234, 17891328, v8
    v_and_b32 v3, 1, v2
    s_lshl_b32 s22, s38, 1
    v_add_u32 v3, s22, v3
    v_bfe_u32 v4, v2, 1, 1
    v_lshlrev_b32 v4, 2, v4
    v_add_u32 v4, s37, v4
    v_lshrrev_b32 v4, 5, v4
    v_cmp_eq_u32 vcc, 7, v4
    v_bfe_u32 v10, v3, 1, 1
    v_lshrrev_b32 v11, 3, v4
    v_cndmask_b32 v10, v11, v10, vcc
    v_and_b32 v11, 3, v3
    v_and_b32 v12, 1, v3
    v_cndmask_b32 v11, v11, v12, vcc
    v_and_b32 v12, 7, v4
    v_lshl_add_u32 v11, v12, 2, v11
    v_lshl_add_u32 v10, v11, 3, v10
    v_lshrrev_b32 v11, 2, v3
    v_lshl_add_u32 v9, v11, 1, v10
    v_lshlrev_b32 v9, 7, v9
    v_add_u32 v235, 17891328, v9
    s_mov_b32 s50, 0
L_w1_p:
    buffer_load_dword v20, v234, s[12:15], 0 offen sc1
    buffer_load_dword v24, v235, s[12:15], 0 offen sc1
    s_add_u32 s50, s50, 1
    s_waitcnt vmcnt(0)
    v_cmp_ne_u32 vcc, s19, v20
    v_cmp_ne_u32 s[26:27], s19, v24
    s_cmp_gt_u32 s50, 262144
    s_cbranch_scc1 L_w1_q
    s_or_b32 s28, vcc_lo, vcc_hi
    s_and_b32 s22, s28, 0x01010101
    s_or_b32 s22, s22, s27
    s_cbranch_scc1 L_w1_p
L_w1_q:
    s_add_u32 s23, s37, 160
    s_lshl_b32 s23, s23, 10
    s_mov_b32 m0, 43264
    s_add_u32 s24, s39, 0
    buffer_load_dwordx4 v224, s[12:15], s24 offen sc1 lds
    s_mov_b32 m0, 44288
    s_add_u32 s24, s39, 491520
    buffer_load_dwordx4 v224, s[12:15], s24 offen sc1 lds
    s_mov_b32 m0, 45312
    s_add_u32 s24, s39, 1024
    buffer_load_dwordx4 v224, s[12:15], s24 offen sc1 lds
    s_mov_b32 m0, 46336
    s_add_u32 s24, s39, 492544
    buffer_load_dwordx4 v224, s[12:15], s24 offen sc1 lds
    s_mov_b32 m0, 47360
    s_add_u32 s24, s39, 2048
    buffer_load_dwordx4 v224, s[12:15], s24 offen sc1 lds
    s_mov_b32 m0, 48384
    s_add_u32 s24, s39, 493568
    buffer_load_dwordx4 v224, s[12:15], s24 offen sc1 lds
    s_mov_b32 m0, 49408
    s_add_u32 s24, s39, 3072
    buffer_load_dwordx4 v224, s[12:15], s24 offen sc1 lds
    s_mov_b32 m0, 50432
    s_add_u32 s24, s39, 494592
    buffer_load_dwordx4 v224, s[12:15], s24 offen sc1 lds
    s_mov_b32 m0, 51456
    s_add_u32 s24, s39, 4096
    buffer_load_dwordx4 v224, s[12:15], s24 offen sc1 lds
    s_mov_b32 m0, 52480
    s_add_u32 s24, s39, 495616
    buffer_load_dwordx4 v224, s[12:15], s24 offen sc1 lds
    s_mov_b32 m0, 1280
    s_add_u32 s24, s23, 0
    buffer_load_dwordx4 v224, s[12:15], s24 offen sc1 lds
    s_mov_b32 m0, 2304
    s_add_u32 s24, s23, 3932160
    buffer_load_dwordx4 v224, s[12:15], s24 offen sc1 lds
    s_mov_b32 m0, 3360
    s_add_u32 s24, s23, 1024
    buffer_load_dwordx4 v224, s[12:15], s24 offen sc1 lds
    s_mov_b32 m0, 4384
    s_add_u32 s24, s23, 3933184
    buffer_load_dwordx4 v224, s[12:15], s24 offen sc1 lds
    s_mov_b32 m0, 5440
    s_add_u32 s24, s23, 2048
    buffer_load_dwordx4 v224, s[12:15], s24 offen sc1 lds
    s_mov_b32 m0, 6464
    s_add_u32 s24, s23, 3934208
    buffer_load_dwordx4 v224, s[12:15], s24 offen sc1 lds
    s_mov_b32 m0, 7520
    s_add_u32 s24, s23, 3072
    buffer_load_dwordx4 v224, s[12:15], s24 offen sc1 lds
    s_mov_b32 m0, 8544
    s_add_u32 s24, s23, 3935232
    buffer_load_dwordx4 v224, s[12:15], s24 offen sc1 lds
    s_mov_b32 m0, 9600
    s_add_u32 s24, s23, 4096
    buffer_load_dwordx4 v224, s[12:15], s24 offen sc1 lds
    s_mov_b32 m0, 10624
    s_add_u32 s24, s23, 3936256
    buffer_load_dwordx4 v224, s[12:15], s24 offen sc1 lds
    s_mov_b32 m0, 11680
    s_add_u32 s24, s23, 163840
    buffer_load_dwordx4 v224, s[12:15], s24 offen sc1 lds
    s_mov_b32 m0, 12704
    s_add_u32 s24, s23, 4096000
    buffer_load_dwordx4 v224, s[12:15], s24 offen sc1 lds
    s_mov_b32 m0, 13760
    s_add_u32 s24, s23, 164864
    buffer_load_dwordx4 v224, s[12:15], s24 offen sc1 lds
    s_mov_b32 m0, 14784
    s_add_u32 s24, s23, 4097024
    buffer_load_dwordx4 v224, s[12:15], s24 offen sc1 lds
    s_mov_b32 m0, 15840
    s_add_u32 s24, s23, 165888
    buffer_load_dwordx4 v224, s[12:15], s24 offen sc1 lds
    s_mov_b32 m0, 16864
    s_add_u32 s24, s23, 4098048
    buffer_load_dwordx4 v224, s[12:15], s24 offen sc1 lds
    s_mov_b32 m0, 17920
    s_add_u32 s24, s23, 166912
    buffer_load_dwordx4 v224, s[12:15], s24 offen sc1 lds
    s_mov_b32 m0, 18944
    s_add_u32 s24, s23, 4099072
    buffer_load_dwordx4 v224, s[12:15], s24 offen sc1 lds
    s_mov_b32 m0, 20000
    s_add_u32 s24, s23, 167936
    buffer_load_dwordx4 v224, s[12:15], s24 offen sc1 lds
    s_mov_b32 m0, 21024
    s_add_u32 s24, s23, 4100096
    buffer_load_dwordx4 v224, s[12:15], s24 offen sc1 lds
    s_mov_b32 s50, 0
    s_branch L_poll_12_c
L_poll_12:
    buffer_load_dword v20, v234, s[12:15], 0 offen sc1
    buffer_load_dword v24, v235, s[12:15], 0 offen sc1
    s_add_u32 s50, s50, 1
    s_waitcnt vmcnt(0)
L_poll_12_c:
    v_xor_b32 v20, s19, v20
    v_xor_b32 v24, s19, v24
    v_or_b32 v20, v20, v24
    v_cmp_ne_u32 vcc, 0, v20
    s_cmp_gt_u32 s50, 262144
    s_cbranch_scc1 L_poll_e_13
    s_cbranch_vccnz L_poll_12
L_poll_e_13:
    s_waitcnt vmcnt(0)
    s_branch L_at_b2
L_attn:
    s_mov_b32 s8, s82
    s_and_b32 s9, s83, 0xffff
    s_mov_b32 s10, 819200
    s_mov_b32 s11, 0x20000
    s_mov_b32 s30, 0
    s_mov_b32 s31, 0
    s_mov_b32 s32, 41984
    s_mov_b32 s34, 4294925312
    s_mov_b32 s35, 20992
L_attn2:
    s_waitcnt lgkmcnt(0)
    v_mov_b64 v[104:105], 0
    v_mov_b64 v[106:107], 0
    v_mov_b64 v[108:109], 0
    v_mov_b64 v[110:111], 0
    v_mov_b64 v[112:113], 0
    v_mov_b64 v[114:115], 0
    v_mov_b64 v[116:117], 0
    v_mov_b64 v[118:119], 0
    v_mov_b64 v[120:121], 0
    v_mov_b64 v[122:123], 0
    v_mov_b64 v[124:125], 0
    v_mov_b64 v[126:127], 0
    v_mov_b64 v[128:129], 0
    v_mov_b64 v[130:131], 0
    v_mov_b64 v[132:133], 0
    v_mov_b64 v[134:135], 0
    v_mov_b64 v[64:65], 0
    v_mov_b64 v[48:49], 0
    v_mov_b64 v[66:67], 0
    v_mov_b64 v[50:51], 0
    v_mov_b64 v[68:69], 0
    v_mov_b64 v[52:53], 0
    v_mov_b64 v[70:71], 0
    v_mov_b64 v[54:55], 0
L_at_b2:
    v_cmp_gt_u32 vcc, 32, v2
    v_xor_b32 v3, 256, v232
    v_xor_b32 v4, 256, v231
    s_waitcnt lgkmcnt(0)
    s_barrier
    ds_read_b64 v[28:29], v225 offset:0
    ds_read_b64 v[30:31], v225 offset:2080
    ds_read_b64 v[32:33], v226 offset:0
    s_cmp_lg_u32 s47, 0
    s_cbranch_scc1 L_at_havem
    ds_read_b64 v[16:17], v3 offset:43264
    ds_read_b64 v[18:19], v3 offset:45312
    ds_read_b64 v[20:21], v4 offset:51456
    ds_read_b64 v[22:23], v232 offset:43264
    ds_read_b64 v[24:25], v232 offset:45312
    ds_read_b64 v[26:27], v231 offset:51456
    s_waitcnt lgkmcnt(0)
    v_cndmask_b32 v20, 0, v20, vcc
    v_cndmask_b32 v21, 0, v21, vcc
    v_cndmask_b32 v26, 0, v26, vcc
    v_cndmask_b32 v27, 0, v27, vcc
L_at_havem:
    s_cmp_eq_u32 s47, 1
    s_cbranch_scc1 L_at_maxpass
    s_waitcnt lgkmcnt(0)
    v_mfma_f32_32x32x16_bf16 v[72:87], v[28:31], v[16:19], 0
    v_mfma_f32_32x32x8_bf16 v[72:87], v[32:33], v[20:21], v[72:87]
    s_add_u32 m0, s44, 20992
    s_nop 0
    buffer_load_dwordx4 v224, s[12:15], s40 offen sc1 lds
    s_add_u32 m0, s45, 20992
    s_nop 0
    buffer_load_dwordx4 v224, s[12:15], s41 offen sc1 lds
    s_cmp_ge_u32 s16, 4
    s_cbranch_scc1 L_at_p3
    s_add_u32 m0, s46, 20992
    s_nop 0
    buffer_load_dwordx4 v224, s[12:15], s42 offen sc1 lds
L_at_p3:
    s_setprio 3
.p2align 6
L_at_loop:
    v_mfma_f32_32x32x16_bf16 v[88:103], v[28:31], v[22:25], 0
    ds_read_b64 v[34:35], v225 offset:256
    ds_read_b64 v[36:37], v225 offset:2336
    ds_read_b64 v[38:39], v226 offset:256
    v_exp_f32 v72, v72
    v_exp_f32 v73, v73
    v_exp_f32 v74, v74
    v_exp_f32 v75, v75
    v_cvt_pk_bf16_f32 v56, v72, v73
    v_mfma_f32_32x32x8_bf16 v[88:103], v[32:33], v[26:27], v[88:103]
    ds_read_b64_tr_b16 v[40:41], v227 offset:0
    ds_read_b64_tr_b16 v[42:43], v227 offset:64
    v_exp_f32 v76, v76
    v_exp_f32 v77, v77
    v_cvt_pk_bf16_f32 v57, v74, v75
    v_exp_f32 v78, v78
    v_exp_f32 v79, v79
    v_cvt_pk_bf16_f32 v58, v76, v77
    v_mfma_f32_32x32x16_bf16 v[120:135], v[48:51], v[64:67], v[120:135]
    ds_read_b64_tr_b16 v[44:45], v227 offset:128
    ds_read_b64_tr_b16 v[46:47], v227 offset:192
    v_exp_f32 v80, v80
    v_exp_f32 v81, v81
    v_cvt_pk_bf16_f32 v59, v78, v79
    v_exp_f32 v82, v82
    v_exp_f32 v83, v83
    v_cvt_pk_bf16_f32 v60, v80, v81
    v_mfma_f32_32x32x16_bf16 v[120:135], v[52:55], v[68:71], v[120:135]
    s_mov_b32 m0, s95
    s_sub_u32 s95, s95, 7680
    buffer_load_dwordx4 v230, s[8:11], s94 offen lds
    s_sub_u32 s94, s94, 61440
    v_exp_f32 v84, v84
    v_exp_f32 v85, v85
    v_cvt_pk_bf16_f32 v61, v82, v83
    v_exp_f32 v86, v86
    v_exp_f32 v87, v87
    v_cvt_pk_bf16_f32 v62, v84, v85
    v_cvt_pk_bf16_f32 v63, v86, v87
    s_waitcnt lgkmcnt(0)
    v_mfma_f32_32x32x16_bf16 v[72:87], v[34:37], v[16:19], 0
    v_exp_f32 v88, v88
    v_exp_f32 v89, v89
    v_exp_f32 v90, v90
    v_exp_f32 v91, v91
    v_cvt_pk_bf16_f32 v64, v88, v89
    v_mfma_f32_32x32x8_bf16 v[72:87], v[38:39], v[20:21], v[72:87]
    s_mov_b32 m0, s95
    s_sub_u32 s95, s95, 7680
    buffer_load_dwordx4 v230, s[8:11], s94 offen lds
    s_sub_u32 s94, s94, 61440
    v_exp_f32 v92, v92
    v_exp_f32 v93, v93
    v_cvt_pk_bf16_f32 v65, v90, v91
    v_exp_f32 v94, v94
    v_exp_f32 v95, v95
    v_cvt_pk_bf16_f32 v66, v92, v93
    v_mfma_f32_32x32x16_bf16 v[104:119], v[40:43], v[56:59], v[104:119]
    v_exp_f32 v96, v96
    v_exp_f32 v97, v97
    v_cvt_pk_bf16_f32 v67, v94, v95
    v_exp_f32 v98, v98
    v_exp_f32 v99, v99
    v_cvt_pk_bf16_f32 v68, v96, v97
    v_mfma_f32_32x32x16_bf16 v[104:119], v[44:47], v[60:63], v[104:119]
    v_exp_f32 v100, v100
    v_exp_f32 v101, v101
    v_cvt_pk_bf16_f32 v69, v98, v99
    v_exp_f32 v102, v102
    v_exp_f32 v103, v103
    v_cvt_pk_bf16_f32 v70, v100, v101
    v_cvt_pk_bf16_f32 v71, v102, v103
    v_mfma_f32_32x32x16_bf16 v[88:103], v[34:37], v[22:25], 0
    s_setprio 2
    ds_read_b64 v[28:29], v225 offset:512
    ds_read_b64 v[30:31], v225 offset:2592
    ds_read_b64 v[32:33], v226 offset:512
    v_exp_f32 v72, v72
    v_exp_f32 v73, v73
    v_exp_f32 v74, v74
    v_exp_f32 v75, v75
    v_cvt_pk_bf16_f32 v56, v72, v73
    v_mfma_f32_32x32x8_bf16 v[88:103], v[38:39], v[26:27], v[88:103]
    ds_read_b64_tr_b16 v[48:49], v227 offset:256
    ds_read_b64_tr_b16 v[50:51], v227 offset:320
    v_exp_f32 v76, v76
    v_exp_f32 v77, v77
    v_cvt_pk_bf16_f32 v57, v74, v75
    v_exp_f32 v78, v78
    v_exp_f32 v79, v79
    v_cvt_pk_bf16_f32 v58, v76, v77
    v_mfma_f32_32x32x16_bf16 v[120:135], v[40:43], v[64:67], v[120:135]
    ds_read_b64_tr_b16 v[52:53], v227 offset:384
    ds_read_b64_tr_b16 v[54:55], v227 offset:448
    v_exp_f32 v80, v80
    v_exp_f32 v81, v81
    v_cvt_pk_bf16_f32 v59, v78, v79
    v_exp_f32 v82, v82
    v_exp_f32 v83, v83
    v_cvt_pk_bf16_f32 v60, v80, v81
    v_mfma_f32_32x32x16_bf16 v[120:135], v[44:47], v[68:71], v[120:135]
    v_exp_f32 v84, v84
    v_exp_f32 v85, v85
    v_cvt_pk_bf16_f32 v61, v82, v83
    v_exp_f32 v86, v86
    v_exp_f32 v87, v87
    v_cvt_pk_bf16_f32 v62, v84, v85
    v_cvt_pk_bf16_f32 v63, v86, v87
    s_waitcnt lgkmcnt(0)
    v_mfma_f32_32x32x16_bf16 v[72:87], v[28:31], v[16:19], 0
    s_cmp_eq_u32 s31, 41984
    s_cselect_b32 s29, s34, s35
    v_exp_f32 v88, v88
    v_exp_f32 v89, v89
    v_exp_f32 v90, v90
    v_exp_f32 v91, v91
    v_cvt_pk_bf16_f32 v64, v88, v89
    v_mfma_f32_32x32x8_bf16 v[72:87], v[32:33], v[20:21], v[72:87]
    v_exp_f32 v92, v92
    v_exp_f32 v93, v93
    v_cvt_pk_bf16_f32 v65, v90, v91
    v_exp_f32 v94, v94
    v_exp_f32 v95, v95
    v_cvt_pk_bf16_f32 v66, v92, v93
    v_mfma_f32_32x32x16_bf16 v[104:119], v[48:51], v[56:59], v[104:119]
    v_exp_f32 v96, v96
    v_exp_f32 v97, v97
    v_cvt_pk_bf16_f32 v67, v94, v95
    v_exp_f32 v98, v98
    v_exp_f32 v99, v99
    v_cvt_pk_bf16_f32 v68, v96, v97
    v_mfma_f32_32x32x16_bf16 v[104:119], v[52:55], v[60:63], v[104:119]
    v_exp_f32 v100, v100
    v_exp_f32 v101, v101
    v_cvt_pk_bf16_f32 v69, v98, v99
    v_exp_f32 v102, v102
    v_exp_f32 v103, v103
    v_cvt_pk_bf16_f32 v70, v100, v101
    v_cvt_pk_bf16_f32 v71, v102, v103
    v_mfma_f32_32x32x16_bf16 v[88:103], v[28:31], v[22:25], 0
    ds_read_b64 v[34:35], v225 offset:768
    ds_read_b64 v[36:37], v225 offset:2848
    ds_read_b64 v[38:39], v226 offset:768
    v_exp_f32 v72, v72
    v_exp_f32 v73, v73
    v_exp_f32 v74, v74
    v_exp_f32 v75, v75
    v_cvt_pk_bf16_f32 v56, v72, v73
    v_mfma_f32_32x32x8_bf16 v[88:103], v[32:33], v[26:27], v[88:103]
    ds_read_b64_tr_b16 v[40:41], v227 offset:512
    ds_read_b64_tr_b16 v[42:43], v227 offset:576
    v_exp_f32 v76, v76
    v_exp_f32 v77, v77
    v_cvt_pk_bf16_f32 v57, v74, v75
    v_exp_f32 v78, v78
    v_exp_f32 v79, v79
    v_cvt_pk_bf16_f32 v58, v76, v77
    v_mfma_f32_32x32x16_bf16 v[120:135], v[48:51], v[64:67], v[120:135]
    s_setprio 1
    ds_read_b64_tr_b16 v[44:45], v227 offset:640
    ds_read_b64_tr_b16 v[46:47], v227 offset:704
    v_exp_f32 v80, v80
    v_exp_f32 v81, v81
    v_cvt_pk_bf16_f32 v59, v78, v79
    v_exp_f32 v82, v82
    v_exp_f32 v83, v83
    v_cvt_pk_bf16_f32 v60, v80, v81
    v_mfma_f32_32x32x16_bf16 v[120:135], v[52:55], v[68:71], v[120:135]
    v_exp_f32 v84, v84
    v_exp_f32 v85, v85
    v_cvt_pk_bf16_f32 v61, v82, v83
    v_exp_f32 v86, v86
    v_exp_f32 v87, v87
    v_cvt_pk_bf16_f32 v62, v84, v85
    v_cvt_pk_bf16_f32 v63, v86, v87
    s_waitcnt lgkmcnt(0)
    v_mfma_f32_32x32x16_bf16 v[72:87], v[34:37], v[16:19], 0
    v_exp_f32 v88, v88
    v_exp_f32 v89, v89
    v_exp_f32 v90, v90
    v_exp_f32 v91, v91
    v_cvt_pk_bf16_f32 v64, v88, v89
    v_mfma_f32_32x32x8_bf16 v[72:87], v[38:39], v[20:21], v[72:87]
    v_add_u32 v225, s29, v225
    v_mad_i32_i24 v226, v229, s29, v226
    v_exp_f32 v92, v92
    v_exp_f32 v93, v93
    v_cvt_pk_bf16_f32 v65, v90, v91
    v_exp_f32 v94, v94
    v_exp_f32 v95, v95
    v_cvt_pk_bf16_f32 v66, v92, v93
    v_mfma_f32_32x32x16_bf16 v[104:119], v[40:43], v[56:59], v[104:119]
    s_setprio 0
    v_exp_f32 v96, v96
    v_exp_f32 v97, v97
    v_cvt_pk_bf16_f32 v67, v94, v95
    v_exp_f32 v98, v98
    v_exp_f32 v99, v99
    v_cvt_pk_bf16_f32 v68, v96, v97
    v_mfma_f32_32x32x16_bf16 v[104:119], v[44:47], v[60:63], v[104:119]
    v_exp_f32 v100, v100
    v_exp_f32 v101, v101
    v_cvt_pk_bf16_f32 v69, v98, v99
    v_exp_f32 v102, v102
    v_exp_f32 v103, v103
    v_cvt_pk_bf16_f32 v70, v100, v101
    v_cvt_pk_bf16_f32 v71, v102, v103
    s_waitcnt vmcnt(0)
    s_barrier
    v_mfma_f32_32x32x16_bf16 v[88:103], v[34:37], v[22:25], 0
    s_setprio 3
    ds_read_b64 v[28:29], v225 offset:0
    ds_read_b64 v[30:31], v225 offset:2080
    ds_read_b64 v[32:33], v226 offset:0
    v_exp_f32 v72, v72
    v_exp_f32 v73, v73
    v_exp_f32 v74, v74
    v_exp_f32 v75, v75
    v_cvt_pk_bf16_f32 v56, v72, v73
    v_mfma_f32_32x32x8_bf16 v[88:103], v[38:39], v[26:27], v[88:103]
    ds_read_b64_tr_b16 v[48:49], v227 offset:768
    ds_read_b64_tr_b16 v[50:51], v227 offset:832
    v_exp_f32 v76, v76
    v_exp_f32 v77, v77
    v_cvt_pk_bf16_f32 v57, v74, v75
    v_exp_f32 v78, v78
    v_exp_f32 v79, v79
    v_cvt_pk_bf16_f32 v58, v76, v77
    v_mfma_f32_32x32x16_bf16 v[120:135], v[40:43], v[64:67], v[120:135]
    ds_read_b64_tr_b16 v[52:53], v227 offset:896
    ds_read_b64_tr_b16 v[54:55], v227 offset:960
    v_exp_f32 v80, v80
    v_exp_f32 v81, v81
    v_cvt_pk_bf16_f32 v59, v78, v79
    v_exp_f32 v82, v82
    v_exp_f32 v83, v83
    v_cvt_pk_bf16_f32 v60, v80, v81
    v_mfma_f32_32x32x16_bf16 v[120:135], v[44:47], v[68:71], v[120:135]
    s_add_u32 m0, s44, s32
    s_add_u32 s40, s40, 491520
    buffer_load_dwordx4 v224, s[12:15], s40 offen sc1 lds
    s_cmp_lg_u32 s36, 0
    s_cbranch_scc1 L_at_fc
L_at_back:
    v_exp_f32 v84, v84
    v_exp_f32 v85, v85
    v_cvt_pk_bf16_f32 v61, v82, v83
    v_exp_f32 v86, v86
    v_exp_f32 v87, v87
    v_cvt_pk_bf16_f32 v62, v84, v85
    v_cvt_pk_bf16_f32 v63, v86, v87
    s_waitcnt lgkmcnt(0)
    v_mfma_f32_32x32x16_bf16 v[72:87], v[28:31], v[16:19], 0
    v_exp_f32 v88, v88
    v_exp_f32 v89, v89
    v_exp_f32 v90, v90
    v_exp_f32 v91, v91
    v_cvt_pk_bf16_f32 v64, v88, v89
    v_mfma_f32_32x32x8_bf16 v[72:87], v[32:33], v[20:21], v[72:87]
    s_add_u32 m0, s45, s32
    s_add_u32 s41, s41, 491520
    buffer_load_dwordx4 v224, s[12:15], s41 offen sc1 lds
    v_exp_f32 v92, v92
    v_exp_f32 v93, v93
    v_cvt_pk_bf16_f32 v65, v90, v91
    v_exp_f32 v94, v94
    v_exp_f32 v95, v95
    v_cvt_pk_bf16_f32 v66, v92, v93
    v_mfma_f32_32x32x16_bf16 v[104:119], v[48:51], v[56:59], v[104:119]
    v_exp_f32 v96, v96
    v_exp_f32 v97, v97
    v_cvt_pk_bf16_f32 v67, v94, v95
    v_exp_f32 v98, v98
    v_exp_f32 v99, v99
    v_cvt_pk_bf16_f32 v68, v96, v97
    v_mfma_f32_32x32x16_bf16 v[104:119], v[52:55], v[60:63], v[104:119]
    s_cmp_eq_u32 s48, 1
    s_cbranch_scc1 L_at_n2
    s_add_u32 m0, s46, s32
    s_add_u32 s42, s42, 491520
    buffer_load_dwordx4 v224, s[12:15], s42 offen sc1 lds
L_at_n2:
    s_mov_b32 s32, s31
    s_add_u32 s31, s31, s29
    v_exp_f32 v100, v100
    v_exp_f32 v101, v101
    v_cvt_pk_bf16_f32 v69, v98, v99
    v_exp_f32 v102, v102
    v_exp_f32 v103, v103
    v_mad_i32_i24 v227, v228, s29, v227
    s_add_u32 s30, s30, 1
    s_cmp_lt_u32 s30, 6
    v_cvt_pk_bf16_f32 v70, v100, v101
    v_cvt_pk_bf16_f32 v71, v102, v103
    s_cbranch_scc1 L_at_loop
    v_mfma_f32_32x32x16_bf16 v[88:103], v[28:31], v[22:25], 0
    ds_read_b64 v[34:35], v225 offset:256
    ds_read_b64 v[36:37], v225 offset:2336
    ds_read_b64 v[38:39], v226 offset:256
    v_exp_f32 v72, v72
    v_exp_f32 v73, v73
    v_exp_f32 v74, v74
    v_exp_f32 v75, v75
    v_cvt_pk_bf16_f32 v56, v72, v73
    v_mfma_f32_32x32x8_bf16 v[88:103], v[32:33], v[26:27], v[88:103]
    ds_read_b64_tr_b16 v[40:41], v227 offset:0
    ds_read_b64_tr_b16 v[42:43], v227 offset:64
    v_exp_f32 v76, v76
    v_exp_f32 v77, v77
    v_cvt_pk_bf16_f32 v57, v74, v75
    v_exp_f32 v78, v78
    v_exp_f32 v79, v79
    v_cvt_pk_bf16_f32 v58, v76, v77
    v_mfma_f32_32x32x16_bf16 v[120:135], v[48:51], v[64:67], v[120:135]
    ds_read_b64_tr_b16 v[44:45], v227 offset:128
    ds_read_b64_tr_b16 v[46:47], v227 offset:192
    v_exp_f32 v80, v80
    v_exp_f32 v81, v81
    v_cvt_pk_bf16_f32 v59, v78, v79
    v_exp_f32 v82, v82
    v_exp_f32 v83, v83
    v_cvt_pk_bf16_f32 v60, v80, v81
    v_mfma_f32_32x32x16_bf16 v[120:135], v[52:55], v[68:71], v[120:135]
    buffer_load_dwordx4 v[136:139], v239, s[12:15], 0 offen sc1
    v_exp_f32 v84, v84
    v_exp_f32 v85, v85
    v_cvt_pk_bf16_f32 v61, v82, v83
    v_exp_f32 v86, v86
    v_exp_f32 v87, v87
    v_cvt_pk_bf16_f32 v62, v84, v85
    v_cvt_pk_bf16_f32 v63, v86, v87
    s_waitcnt lgkmcnt(0)
    v_mfma_f32_32x32x16_bf16 v[72:87], v[34:37], v[16:19], 0
    v_exp_f32 v88, v88
    v_exp_f32 v89, v89
    v_exp_f32 v90, v90
    v_exp_f32 v91, v91
    v_cvt_pk_bf16_f32 v64, v88, v89
    v_mfma_f32_32x32x8_bf16 v[72:87], v[38:39], v[20:21], v[72:87]
    v_exp_f32 v92, v92
    v_exp_f32 v93, v93
    v_cvt_pk_bf16_f32 v65, v90, v91
    v_exp_f32 v94, v94
    v_exp_f32 v95, v95
    v_cvt_pk_bf16_f32 v66, v92, v93
    v_mfma_f32_32x32x16_bf16 v[104:119], v[40:43], v[56:59], v[104:119]
    v_exp_f32 v96, v96
    v_exp_f32 v97, v97
    v_cvt_pk_bf16_f32 v67, v94, v95
    v_exp_f32 v98, v98
    v_exp_f32 v99, v99
    v_cvt_pk_bf16_f32 v68, v96, v97
    v_mfma_f32_32x32x16_bf16 v[104:119], v[44:47], v[60:63], v[104:119]
    v_exp_f32 v100, v100
    v_exp_f32 v101, v101
    v_cvt_pk_bf16_f32 v69, v98, v99
    v_exp_f32 v102, v102
    v_exp_f32 v103, v103
    v_cvt_pk_bf16_f32 v70, v100, v101
    v_cvt_pk_bf16_f32 v71, v102, v103
    v_mfma_f32_32x32x16_bf16 v[88:103], v[34:37], v[22:25], 0
    s_setprio 2
    ds_read_b64 v[28:29], v225 offset:512
    ds_read_b64 v[30:31], v225 offset:2592
    ds_read_b64 v[32:33], v226 offset:512
    v_exp_f32 v72, v72
    v_exp_f32 v73, v73
    v_exp_f32 v74, v74
    v_exp_f32 v75, v75
    v_cvt_pk_bf16_f32 v56, v72, v73
    v_mfma_f32_32x32x8_bf16 v[88:103], v[38:39], v[26:27], v[88:103]
    ds_read_b64_tr_b16 v[48:49], v227 offset:256
    ds_read_b64_tr_b16 v[50:51], v227 offset:320
    v_exp_f32 v76, v76
    v_exp_f32 v77, v77
    v_cvt_pk_bf16_f32 v57, v74, v75
    v_exp_f32 v78, v78
    v_exp_f32 v79, v79
    v_cvt_pk_bf16_f32 v58, v76, v77
    v_mfma_f32_32x32x16_bf16 v[120:135], v[40:43], v[64:67], v[120:135]
    ds_read_b64_tr_b16 v[52:53], v227 offset:384
    ds_read_b64_tr_b16 v[54:55], v227 offset:448
    v_exp_f32 v80, v80
    v_exp_f32 v81, v81
    v_cvt_pk_bf16_f32 v59, v78, v79
    v_exp_f32 v82, v82
    v_exp_f32 v83, v83
    v_cvt_pk_bf16_f32 v60, v80, v81
    v_mfma_f32_32x32x16_bf16 v[120:135], v[44:47], v[68:71], v[120:135]
    v_exp_f32 v84, v84
    v_exp_f32 v85, v85
    v_cvt_pk_bf16_f32 v61, v82, v83
    v_exp_f32 v86, v86
    v_exp_f32 v87, v87
    v_cvt_pk_bf16_f32 v62, v84, v85
    v_cvt_pk_bf16_f32 v63, v86, v87
    s_waitcnt lgkmcnt(0)
    v_mfma_f32_32x32x16_bf16 v[72:87], v[28:31], v[16:19], 0
    s_mov_b32 s29, s35
    v_exp_f32 v88, v88
    v_exp_f32 v89, v89
    v_exp_f32 v90, v90
    v_exp_f32 v91, v91
    v_cvt_pk_bf16_f32 v64, v88, v89
    v_mfma_f32_32x32x8_bf16 v[72:87], v[32:33], v[20:21], v[72:87]
    v_exp_f32 v92, v92
    v_exp_f32 v93, v93
    v_cvt_pk_bf16_f32 v65, v90, v91
    v_exp_f32 v94, v94
    v_exp_f32 v95, v95
    v_cvt_pk_bf16_f32 v66, v92, v93
    v_mfma_f32_32x32x16_bf16 v[104:119], v[48:51], v[56:59], v[104:119]
    v_exp_f32 v96, v96
    v_exp_f32 v97, v97
    v_cvt_pk_bf16_f32 v67, v94, v95
    v_exp_f32 v98, v98
    v_exp_f32 v99, v99
    v_cvt_pk_bf16_f32 v68, v96, v97
    v_mfma_f32_32x32x16_bf16 v[104:119], v[52:55], v[60:63], v[104:119]
    v_exp_f32 v100, v100
    v_exp_f32 v101, v101
    v_cvt_pk_bf16_f32 v69, v98, v99
    v_exp_f32 v102, v102
    v_exp_f32 v103, v103
    v_cvt_pk_bf16_f32 v70, v100, v101
    v_cvt_pk_bf16_f32 v71, v102, v103
    v_mfma_f32_32x32x16_bf16 v[88:103], v[28:31], v[22:25], 0
    ds_read_b64 v[34:35], v225 offset:768
    ds_read_b64 v[36:37], v225 offset:2848
    ds_read_b64 v[38:39], v226 offset:768
    v_exp_f32 v72, v72
    v_exp_f32 v73, v73
    v_exp_f32 v74, v74
    v_exp_f32 v75, v75
    v_cvt_pk_bf16_f32 v56, v72, v73
    v_mfma_f32_32x32x8_bf16 v[88:103], v[32:33], v[26:27], v[88:103]
    ds_read_b64_tr_b16 v[40:41], v227 offset:512
    ds_read_b64_tr_b16 v[42:43], v227 offset:576
    v_exp_f32 v76, v76
    v_exp_f32 v77, v77
    v_cvt_pk_bf16_f32 v57, v74, v75
    v_exp_f32 v78, v78
    v_exp_f32 v79, v79
    v_cvt_pk_bf16_f32 v58, v76, v77
    v_mfma_f32_32x32x16_bf16 v[120:135], v[48:51], v[64:67], v[120:135]
    s_setprio 1
    ds_read_b64_tr_b16 v[44:45], v227 offset:640
    ds_read_b64_tr_b16 v[46:47], v227 offset:704
    v_exp_f32 v80, v80
    v_exp_f32 v81, v81
    v_cvt_pk_bf16_f32 v59, v78, v79
    v_exp_f32 v82, v82
    v_exp_f32 v83, v83
    v_cvt_pk_bf16_f32 v60, v80, v81
    v_mfma_f32_32x32x16_bf16 v[120:135], v[52:55], v[68:71], v[120:135]
    v_exp_f32 v84, v84
    v_exp_f32 v85, v85
    v_cvt_pk_bf16_f32 v61, v82, v83
    v_exp_f32 v86, v86
    v_exp_f32 v87, v87
    v_cvt_pk_bf16_f32 v62, v84, v85
    v_cvt_pk_bf16_f32 v63, v86, v87
    s_waitcnt lgkmcnt(0)
    v_mfma_f32_32x32x16_bf16 v[72:87], v[34:37], v[16:19], 0
    v_exp_f32 v88, v88
    v_exp_f32 v89, v89
    v_exp_f32 v90, v90
    v_exp_f32 v91, v91
    v_cvt_pk_bf16_f32 v64, v88, v89
    v_mfma_f32_32x32x8_bf16 v[72:87], v[38:39], v[20:21], v[72:87]
    v_add_u32 v225, s29, v225
    v_mad_i32_i24 v226, v229, s29, v226
    v_exp_f32 v92, v92
    v_exp_f32 v93, v93
    v_cvt_pk_bf16_f32 v65, v90, v91
    v_exp_f32 v94, v94
    v_exp_f32 v95, v95
    v_cvt_pk_bf16_f32 v66, v92, v93
    v_mfma_f32_32x32x16_bf16 v[104:119], v[40:43], v[56:59], v[104:119]
    s_setprio 0
    v_exp_f32 v96, v96
    v_exp_f32 v97, v97
    v_cvt_pk_bf16_f32 v67, v94, v95
    v_exp_f32 v98, v98
    v_exp_f32 v99, v99
    v_cvt_pk_bf16_f32 v68, v96, v97
    v_mfma_f32_32x32x16_bf16 v[104:119], v[44:47], v[60:63], v[104:119]
    v_exp_f32 v100, v100
    v_exp_f32 v101, v101
    v_cvt_pk_bf16_f32 v69, v98, v99
    v_exp_f32 v102, v102
    v_exp_f32 v103, v103
    v_cvt_pk_bf16_f32 v70, v100, v101
    v_cvt_pk_bf16_f32 v71, v102, v103
    s_waitcnt vmcnt(0)
    s_barrier
    v_mfma_f32_32x32x16_bf16 v[88:103], v[34:37], v[22:25], 0
    s_setprio 3
    ds_read_b64 v[28:29], v225 offset:0
    ds_read_b64 v[30:31], v225 offset:2080
    ds_read_b64 v[32:33], v226 offset:0
    v_exp_f32 v72, v72
    v_exp_f32 v73, v73
    v_exp_f32 v74, v74
    v_exp_f32 v75, v75
    v_cvt_pk_bf16_f32 v56, v72, v73
    v_mfma_f32_32x32x8_bf16 v[88:103], v[38:39], v[26:27], v[88:103]
    ds_read_b64_tr_b16 v[48:49], v227 offset:768
    ds_read_b64_tr_b16 v[50:51], v227 offset:832
    v_exp_f32 v76, v76
    v_exp_f32 v77, v77
    v_cvt_pk_bf16_f32 v57, v74, v75
    v_exp_f32 v78, v78
    v_exp_f32 v79, v79
    v_cvt_pk_bf16_f32 v58, v76, v77
    v_mfma_f32_32x32x16_bf16 v[120:135], v[40:43], v[64:67], v[120:135]
    ds_read_b64_tr_b16 v[52:53], v227 offset:896
    ds_read_b64_tr_b16 v[54:55], v227 offset:960
    v_exp_f32 v80, v80
    v_exp_f32 v81, v81
    v_cvt_pk_bf16_f32 v59, v78, v79
    v_exp_f32 v82, v82
    v_exp_f32 v83, v83
    v_cvt_pk_bf16_f32 v60, v80, v81
    v_mfma_f32_32x32x16_bf16 v[120:135], v[44:47], v[68:71], v[120:135]
    s_mov_b32 s50, 0
    s_branch L_poll_14_c
L_poll_14:
    buffer_load_dwordx4 v[136:139], v239, s[12:15], 0 offen sc1
    s_add_u32 s50, s50, 1
    s_waitcnt vmcnt(0)
L_poll_14_c:
    v_xor_b32 v136, s19, v136
    v_xor_b32 v137, s19, v137
    v_xor_b32 v138, s19, v138
    v_xor_b32 v139, s19, v139
    v_or_b32 v136, v136, v137
    v_or_b32 v136, v136, v138
    v_or_b32 v136, v136, v139
    v_cmp_ne_u32 vcc, 0, v136
    s_cmp_gt_u32 s50, 262144
    s_cbranch_scc1 L_poll_e_15
    s_cbranch_vccnz L_poll_14
L_poll_e_15:
    s_lshl_b32 s23, s16, 10
    s_add_u32 m0, s23, 50816
    s_cmp_ge_u32 s16, 2
    buffer_load_dwordx4 v238, s[12:15], s21 offen sc1 lds
    s_cbranch_scc1 L_at_y1
    s_add_u32 m0, m0, 8192
    s_add_u32 s22, s21, 278528
    buffer_load_dwordx4 v238, s[12:15], s22 offen sc1 lds
L_at_y1:
    v_exp_f32 v84, v84
    v_exp_f32 v85, v85
    v_cvt_pk_bf16_f32 v61, v82, v83
    v_exp_f32 v86, v86
    v_exp_f32 v87, v87
    v_cvt_pk_bf16_f32 v62, v84, v85
    v_cvt_pk_bf16_f32 v63, v86, v87
    s_waitcnt lgkmcnt(0)
    v_mfma_f32_32x32x16_bf16 v[72:87], v[28:31], v[16:19], 0
    v_exp_f32 v88, v88
    v_exp_f32 v89, v89
    v_exp_f32 v90, v90
    v_exp_f32 v91, v91
    v_cvt_pk_bf16_f32 v64, v88, v89
    v_mfma_f32_32x32x8_bf16 v[72:87], v[32:33], v[20:21], v[72:87]
    v_exp_f32 v92, v92
    v_exp_f32 v93, v93
    v_cvt_pk_bf16_f32 v65, v90, v91
    v_exp_f32 v94, v94
    v_exp_f32 v95, v95
    v_cvt_pk_bf16_f32 v66, v92, v93
    v_mfma_f32_32x32x16_bf16 v[104:119], v[48:51], v[56:59], v[104:119]
    v_exp_f32 v96, v96
    v_exp_f32 v97, v97
    v_cvt_pk_bf16_f32 v67, v94, v95
    v_exp_f32 v98, v98
    v_exp_f32 v99, v99
    v_cvt_pk_bf16_f32 v68, v96, v97
    v_mfma_f32_32x32x16_bf16 v[104:119], v[52:55], v[60:63], v[104:119]
    v_exp_f32 v100, v100
    v_exp_f32 v101, v101
    v_cvt_pk_bf16_f32 v69, v98, v99
    v_exp_f32 v102, v102
    v_exp_f32 v103, v103
    v_mad_i32_i24 v227, v228, s29, v227
    v_cvt_pk_bf16_f32 v70, v100, v101
    v_cvt_pk_bf16_f32 v71, v102, v103
    v_mfma_f32_32x32x16_bf16 v[88:103], v[28:31], v[22:25], 0
    ds_read_b64 v[34:35], v225 offset:256
    ds_read_b64 v[36:37], v225 offset:2336
    ds_read_b64 v[38:39], v226 offset:256
    v_exp_f32 v72, v72
    v_exp_f32 v73, v73
    v_exp_f32 v74, v74
    v_exp_f32 v75, v75
    v_cvt_pk_bf16_f32 v56, v72, v73
    v_mfma_f32_32x32x8_bf16 v[88:103], v[32:33], v[26:27], v[88:103]
    ds_read_b64_tr_b16 v[40:41], v227 offset:0
    ds_read_b64_tr_b16 v[42:43], v227 offset:64
    v_exp_f32 v76, v76
    v_exp_f32 v77, v77
    v_cvt_pk_bf16_f32 v57, v74, v75
    v_exp_f32 v78, v78
    v_exp_f32 v79, v79
    v_cvt_pk_bf16_f32 v58, v76, v77
    v_mfma_f32_32x32x16_bf16 v[120:135], v[48:51], v[64:67], v[120:135]
    ds_read_b64_tr_b16 v[44:45], v227 offset:128
    ds_read_b64_tr_b16 v[46:47], v227 offset:192
    v_exp_f32 v80, v80
    v_exp_f32 v81, v81
    v_cvt_pk_bf16_f32 v59, v78, v79
    v_exp_f32 v82, v82
    v_exp_f32 v83, v83
    v_cvt_pk_bf16_f32 v60, v80, v81
    v_mfma_f32_32x32x16_bf16 v[120:135], v[52:55], v[68:71], v[120:135]
    s_mov_b32 m0, s95
    s_sub_u32 s95, s95, 7680
    buffer_load_dwordx4 v230, s[8:11], s94 offen lds
    s_sub_u32 s94, s94, 61440
    v_exp_f32 v84, v84
    v_exp_f32 v85, v85
    v_cvt_pk_bf16_f32 v61, v82, v83
    v_exp_f32 v86, v86
    v_exp_f32 v87, v87
    v_cvt_pk_bf16_f32 v62, v84, v85
    v_cvt_pk_bf16_f32 v63, v86, v87
    s_waitcnt lgkmcnt(0)
    v_mfma_f32_32x32x16_bf16 v[72:87], v[34:37], v[16:19], 0
    v_exp_f32 v88, v88
    v_exp_f32 v89, v89
    v_exp_f32 v90, v90
    v_exp_f32 v91, v91
    v_cvt_pk_bf16_f32 v64, v88, v89
    v_mfma_f32_32x32x8_bf16 v[72:87], v[38:39], v[20:21], v[72:87]
    s_cmp_ge_u32 s16, 3
    s_cbranch_scc1 L_at_w3
    s_mov_b32 m0, s95
    s_sub_u32 s95, s95, 7680
    buffer_load_dwordx4 v230, s[8:11], s94 offen lds
    s_sub_u32 s94, s94, 61440
L_at_w3:
    v_exp_f32 v92, v92
    v_exp_f32 v93, v93
    v_cvt_pk_bf16_f32 v65, v90, v91
    v_exp_f32 v94, v94
    v_exp_f32 v95, v95
    v_cvt_pk_bf16_f32 v66, v92, v93
    v_mfma_f32_32x32x16_bf16 v[104:119], v[40:43], v[56:59], v[104:119]
    v_exp_f32 v96, v96
    v_exp_f32 v97, v97
    v_cvt_pk_bf16_f32 v67, v94, v95
    v_exp_f32 v98, v98
    v_exp_f32 v99, v99
    v_cvt_pk_bf16_f32 v68, v96, v97
    v_mfma_f32_32x32x16_bf16 v[104:119], v[44:47], v[60:63], v[104:119]
    v_exp_f32 v100, v100
    v_exp_f32 v101, v101
    v_cvt_pk_bf16_f32 v69, v98, v99
    v_exp_f32 v102, v102
    v_exp_f32 v103, v103
    v_cvt_pk_bf16_f32 v70, v100, v101
    v_cvt_pk_bf16_f32 v71, v102, v103
    v_mfma_f32_32x32x16_bf16 v[88:103], v[34:37], v[22:25], 0
    s_setprio 2
    ds_read_b64 v[28:29], v225 offset:512
    ds_read_b64 v[30:31], v225 offset:2592
    ds_read_b64 v[32:33], v226 offset:512
    v_exp_f32 v72, v72
    v_exp_f32 v73, v73
    v_exp_f32 v74, v74
    v_exp_f32 v75, v75
    v_cvt_pk_bf16_f32 v56, v72, v73
    v_mfma_f32_32x32x8_bf16 v[88:103], v[38:39], v[26:27], v[88:103]
    ds_read_b64_tr_b16 v[48:49], v227 offset:256
    ds_read_b64_tr_b16 v[50:51], v227 offset:320
    v_exp_f32 v76, v76
    v_exp_f32 v77, v77
    v_cvt_pk_bf16_f32 v57, v74, v75
    v_exp_f32 v78, v78
    v_exp_f32 v79, v79
    v_cvt_pk_bf16_f32 v58, v76, v77
    v_mfma_f32_32x32x16_bf16 v[120:135], v[40:43], v[64:67], v[120:135]
    ds_read_b64_tr_b16 v[52:53], v227 offset:384
    ds_read_b64_tr_b16 v[54:55], v227 offset:448
    v_exp_f32 v80, v80
    v_exp_f32 v81, v81
    v_cvt_pk_bf16_f32 v59, v78, v79
    v_exp_f32 v82, v82
    v_exp_f32 v83, v83
    v_cvt_pk_bf16_f32 v60, v80, v81
    v_mfma_f32_32x32x16_bf16 v[120:135], v[44:47], v[68:71], v[120:135]
    v_exp_f32 v84, v84
    v_exp_f32 v85, v85
    v_cvt_pk_bf16_f32 v61, v82, v83
    v_exp_f32 v86, v86
    v_exp_f32 v87, v87
    v_cvt_pk_bf16_f32 v62, v84, v85
    v_cvt_pk_bf16_f32 v63, v86, v87
    s_waitcnt lgkmcnt(0)
    v_mfma_f32_32x32x16_bf16 v[72:87], v[28:31], v[16:19], 0
    v_exp_f32 v88, v88
    v_exp_f32 v89, v89
    v_exp_f32 v90, v90
    v_exp_f32 v91, v91
    v_cvt_pk_bf16_f32 v64, v88, v89
    v_mfma_f32_32x32x8_bf16 v[72:87], v[32:33], v[20:21], v[72:87]
    v_exp_f32 v92, v92
    v_exp_f32 v93, v93
    v_cvt_pk_bf16_f32 v65, v90, v91
    v_exp_f32 v94, v94
    v_exp_f32 v95, v95
    v_cvt_pk_bf16_f32 v66, v92, v93
    v_mfma_f32_32x32x16_bf16 v[104:119], v[48:51], v[56:59], v[104:119]
    v_exp_f32 v96, v96
    v_exp_f32 v97, v97
    v_cvt_pk_bf16_f32 v67, v94, v95
    v_exp_f32 v98, v98
    v_exp_f32 v99, v99
    v_cvt_pk_bf16_f32 v68, v96, v97
    v_mfma_f32_32x32x16_bf16 v[104:119], v[52:55], v[60:63], v[104:119]
    v_exp_f32 v100, v100
    v_exp_f32 v101, v101
    v_cvt_pk_bf16_f32 v69, v98, v99
    v_exp_f32 v102, v102
    v_exp_f32 v103, v103
    v_cvt_pk_bf16_f32 v70, v100, v101
    v_cvt_pk_bf16_f32 v71, v102, v103
    v_mfma_f32_32x32x16_bf16 v[88:103], v[28:31], v[22:25], 0
    ds_read_b64 v[34:35], v225 offset:768
    ds_read_b64 v[36:37], v225 offset:2848
    ds_read_b64 v[38:39], v226 offset:768
    v_exp_f32 v72, v72
    v_exp_f32 v73, v73
    v_exp_f32 v74, v74
    v_exp_f32 v75, v75
    v_cvt_pk_bf16_f32 v56, v72, v73
    v_mfma_f32_32x32x8_bf16 v[88:103], v[32:33], v[26:27], v[88:103]
    ds_read_b64_tr_b16 v[40:41], v227 offset:512
    ds_read_b64_tr_b16 v[42:43], v227 offset:576
    v_exp_f32 v76, v76
    v_exp_f32 v77, v77
    v_cvt_pk_bf16_f32 v57, v74, v75
    v_exp_f32 v78, v78
    v_exp_f32 v79, v79
    v_cvt_pk_bf16_f32 v58, v76, v77
    v_mfma_f32_32x32x16_bf16 v[120:135], v[48:51], v[64:67], v[120:135]
    s_setprio 1
    ds_read_b64_tr_b16 v[44:45], v227 offset:640
    ds_read_b64_tr_b16 v[46:47], v227 offset:704
    v_exp_f32 v80, v80
    v_exp_f32 v81, v81
    v_cvt_pk_bf16_f32 v59, v78, v79
    v_exp_f32 v82, v82
    v_exp_f32 v83, v83
    v_cvt_pk_bf16_f32 v60, v80, v81
    v_mfma_f32_32x32x16_bf16 v[120:135], v[52:55], v[68:71], v[120:135]
    v_exp_f32 v84, v84
    v_exp_f32 v85, v85
    v_cvt_pk_bf16_f32 v61, v82, v83
    v_exp_f32 v86, v86
    v_exp_f32 v87, v87
    v_cvt_pk_bf16_f32 v62, v84, v85
    v_cvt_pk_bf16_f32 v63, v86, v87
    s_waitcnt lgkmcnt(0)
    v_mfma_f32_32x32x16_bf16 v[72:87], v[34:37], v[16:19], 0
    v_exp_f32 v88, v88
    v_exp_f32 v89, v89
    v_exp_f32 v90, v90
    v_exp_f32 v91, v91
    v_cvt_pk_bf16_f32 v64, v88, v89
    v_mfma_f32_32x32x8_bf16 v[72:87], v[38:39], v[20:21], v[72:87]
    v_exp_f32 v92, v92
    v_exp_f32 v93, v93
    v_cvt_pk_bf16_f32 v65, v90, v91
    v_exp_f32 v94, v94
    v_exp_f32 v95, v95
    v_cvt_pk_bf16_f32 v66, v92, v93
    v_mfma_f32_32x32x16_bf16 v[104:119], v[40:43], v[56:59], v[104:119]
    s_setprio 0
    v_exp_f32 v96, v96
    v_exp_f32 v97, v97
    v_cvt_pk_bf16_f32 v67, v94, v95
    v_exp_f32 v98, v98
    v_exp_f32 v99, v99
    v_cvt_pk_bf16_f32 v68, v96, v97
    v_mfma_f32_32x32x16_bf16 v[104:119], v[44:47], v[60:63], v[104:119]
    v_exp_f32 v100, v100
    v_exp_f32 v101, v101
    v_cvt_pk_bf16_f32 v69, v98, v99
    v_exp_f32 v102, v102
    v_exp_f32 v103, v103
    v_cvt_pk_bf16_f32 v70, v100, v101
    v_cvt_pk_bf16_f32 v71, v102, v103
    s_waitcnt vmcnt(0)
    s_barrier
    v_mfma_f32_32x32x16_bf16 v[88:103], v[34:37], v[22:25], 0
    s_setprio 3
    ds_read_b64_tr_b16 v[48:49], v227 offset:768
    ds_read_b64_tr_b16 v[50:51], v227 offset:832
    ds_read_b64_tr_b16 v[52:53], v227 offset:896
    v_exp_f32 v72, v72
    v_exp_f32 v73, v73
    v_exp_f32 v74, v74
    v_exp_f32 v75, v75
    v_cvt_pk_bf16_f32 v56, v72, v73
    v_mfma_f32_32x32x8_bf16 v[88:103], v[38:39], v[26:27], v[88:103]
    ds_read_b64_tr_b16 v[54:55], v227 offset:960
    v_exp_f32 v76, v76
    v_exp_f32 v77, v77
    v_cvt_pk_bf16_f32 v57, v74, v75
    v_exp_f32 v78, v78
    v_exp_f32 v79, v79
    v_cvt_pk_bf16_f32 v58, v76, v77
    v_mfma_f32_32x32x16_bf16 v[120:135], v[40:43], v[64:67], v[120:135]
    v_exp_f32 v80, v80
    v_exp_f32 v81, v81
    v_cvt_pk_bf16_f32 v59, v78, v79
    v_exp_f32 v82, v82
    v_exp_f32 v83, v83
    v_cvt_pk_bf16_f32 v60, v80, v81
    v_mfma_f32_32x32x16_bf16 v[120:135], v[44:47], v[68:71], v[120:135]
    v_exp_f32 v84, v84
    v_exp_f32 v85, v85
    v_cvt_pk_bf16_f32 v61, v82, v83
    v_exp_f32 v86, v86
    v_exp_f32 v87, v87
    v_cvt_pk_bf16_f32 v62, v84, v85
    v_cvt_pk_bf16_f32 v63, v86, v87
    s_waitcnt lgkmcnt(0)
    s_setprio 2
    v_exp_f32 v88, v88
    v_exp_f32 v89, v89
    v_exp_f32 v90, v90
    v_exp_f32 v91, v91
    v_cvt_pk_bf16_f32 v64, v88, v89
    v_exp_f32 v92, v92
    v_exp_f32 v93, v93
    v_cvt_pk_bf16_f32 v65, v90, v91
    v_exp_f32 v94, v94
    v_exp_f32 v95, v95
    v_cvt_pk_bf16_f32 v66, v92, v93
    v_mfma_f32_32x32x16_bf16 v[104:119], v[48:51], v[56:59], v[104:119]
    s_setprio 1
    v_exp_f32 v96, v96
    v_exp_f32 v97, v97
    v_cvt_pk_bf16_f32 v67, v94, v95
    v_exp_f32 v98, v98
    v_exp_f32 v99, v99
    v_cvt_pk_bf16_f32 v68, v96, v97
    v_mfma_f32_32x32x16_bf16 v[104:119], v[52:55], v[60:63], v[104:119]
    s_setprio 0
    v_exp_f32 v100, v100
    v_exp_f32 v101, v101
    v_cvt_pk_bf16_f32 v69, v98, v99
    v_exp_f32 v102, v102
    v_exp_f32 v103, v103
    v_cvt_pk_bf16_f32 v70, v100, v101
    v_cvt_pk_bf16_f32 v71, v102, v103
    s_nop 0
    v_mfma_f32_32x32x16_bf16 v[120:135], v[48:51], v[64:67], v[120:135]
    s_setprio 0
    s_mul_i32 s22, s16, 3072
    v_add_u32 v4, s22, v224
    s_xor_b32 s22, s16, 4
    s_mul_i32 s22, s22, 3072
    v_add_u32 v5, s22, v224
    v_mfma_f32_32x32x16_bf16 v[120:135], v[52:55], v[68:71], v[120:135]
    ds_write_b128 v4, v[104:107] offset:1280
    ds_write_b128 v4, v[108:111] offset:2304
    ds_write_b128 v4, v[112:115] offset:3328
    v_mov_b64 v[6:7], 1
    s_mov_b32 s24, 0x76800000
    v_pk_add_f32 v[88:89], v[104:105], v[106:107]
    v_pk_add_f32 v[88:89], v[88:89], v[108:109]
    v_pk_add_f32 v[88:89], v[88:89], v[110:111]
    v_pk_add_f32 v[88:89], v[88:89], v[112:113]
    v_pk_add_f32 v[88:89], v[88:89], v[114:115]
    s_nop 1
    v_pk_add_f32 v[88:89], v[88:89], v[120:121]
    v_pk_add_f32 v[88:89], v[88:89], v[122:123]
    v_pk_add_f32 v[88:89], v[88:89], v[124:125]
    v_pk_add_f32 v[88:89], v[88:89], v[126:127]
    v_pk_add_f32 v[88:89], v[88:89], v[128:129]
    v_pk_add_f32 v[88:89], v[88:89], v[130:131]
    v_add_f32 v88, v88, v89
    v_add_f32 v89, v116, v132
    v_mul_f32 v88, 0x37000000, v88
    s_lshl_b32 s22, s51, 1
    v_add_f32 v88, abs(v88), v89
    s_add_u32 s22, s22, s48
    v_cmp_ngt_f32 vcc, s24, v88
    v_min_f32 v91, v116, v132
    s_mov_b32 s24, 0x21800000
    v_cmp_gt_f32 s[26:27], s24, v91
    s_mul_i32 s22, s22, 40960
    s_or_b64 vcc, vcc, s[26:27]
    s_cbranch_vccz L_at_nf
    ds_write_b32 v7, v6 offset:0
L_at_nf:
    s_add_u32 s23, s22, s55
    s_add_u32 s22, s22, s54
    s_waitcnt lgkmcnt(0)
    s_barrier
    ds_read_b32 v6, v7 offset:0
    ds_read_b128 v[80:83], v5 offset:3328
    ds_read_b128 v[72:75], v5 offset:1280
    ds_read_b128 v[76:79], v5 offset:2304
    s_waitcnt lgkmcnt(2)
    v_readfirstlane_b32 s26, v6
    v_pk_add_f32 v[128:129], v[128:129], v[80:81]
    v_pk_add_f32 v[130:131], v[130:131], v[82:83]
    v_rcp_f32 v88, v128
    s_cmp_gt_u32 s26, s47
    v_mov_b32 v89, v88
    s_cbranch_scc1 L_at_fallback
    s_waitcnt lgkmcnt(0)
    v_permlane32_swap_b32 v88, v89
    v_pk_add_f32 v[120:121], v[120:121], v[72:73]
    v_pk_add_f32 v[122:123], v[122:123], v[74:75]
    v_pk_add_f32 v[124:125], v[124:125], v[76:77]
    v_pk_add_f32 v[126:127], v[126:127], v[78:79]
    v_pk_mul_f32 v[120:121], v[120:121], v[88:89] op_sel:[0,1] op_sel_hi:[1,1]
    v_pk_mul_f32 v[122:123], v[122:123], v[88:89] op_sel:[0,1] op_sel_hi:[1,1]
    v_pk_mul_f32 v[124:125], v[124:125], v[88:89] op_sel:[0,1] op_sel_hi:[1,1]
    v_pk_mul_f32 v[126:127], v[126:127], v[88:89] op_sel:[0,1] op_sel_hi:[1,1]
    v_pk_mul_f32 v[128:129], v[128:129], v[88:89] op_sel:[0,1] op_sel_hi:[1,1]
    v_pk_mul_f32 v[130:131], v[130:131], v[88:89] op_sel:[0,1] op_sel_hi:[1,1]
    v_cvt_pk_bf16_f32 v56, v120, v121
    v_cvt_pk_bf16_f32 v57, v122, v123
    v_cvt_pk_bf16_f32 v58, v124, v125
    v_cvt_pk_bf16_f32 v59, v126, v127
    v_cvt_pk_bf16_f32 v60, v128, v129
    v_cvt_pk_bf16_f32 v61, v130, v131
    buffer_store_dwordx4 v[56:59], v236, s[12:15], s22 offen sc1
    s_mov_b32 exec_hi, 0
    buffer_store_dwordx2 v[60:61], v237, s[12:15], s23 offen sc1
    s_mov_b32 exec_hi, -1
    s_mov_b32 s8, s84
    s_and_b32 s9, s85, 0xffff
    s_mov_b32 s10, 5242880
    s_mov_b32 s11, 0x20000
    v_mov_b32 v5, v224
    v_lshlrev_b32 v1, 3, v2
    s_mov_b32 s50, 0
    s_mov_b32 s29, 15
    s_add_u32 s27, s96, 4096
    s_mul_i32 s22, s51, 5120
    v_add_u32 v6, s22, v5
    s_cmp_eq_u32 s48, 1
    s_cbranch_scc1 L_t_ny
    ds_read_b64_tr_b16 v[108:109], v253 offset:50816
    ds_read_b64_tr_b16 v[110:111], v253 offset:52864
    ds_read_b64_tr_b16 v[112:113], v253 offset:54912
    ds_read_b64_tr_b16 v[114:115], v253 offset:56960
    ds_read_b64_tr_b16 v[116:117], v253 offset:59008
    s_waitcnt lgkmcnt(4)
    ds_write_b64 v251, v[108:109] offset:25856
    s_waitcnt lgkmcnt(4)
    ds_write_b64 v251, v[110:111] offset:25888
    s_waitcnt lgkmcnt(4)
    ds_write_b64 v251, v[112:113] offset:25920
    s_waitcnt lgkmcnt(4)
    ds_write_b64 v251, v[114:115] offset:25952
    s_waitcnt lgkmcnt(4)
    ds_write_b64 v251, v[116:117] offset:25984
    ds_read_b128 v[88:91], v6 offset:25856
    ds_read_b128 v[92:95], v6 offset:26816
    ds_read_b128 v[96:99], v6 offset:27776
    s_mov_b32 exec_hi, 0x0fffffff
    s_add_u32 s22, s98, 15360
    s_add_u32 s23, s98, 30720
    s_waitcnt lgkmcnt(2)
    buffer_store_dwordx4 v[88:91], v250, s[8:11], s98 offen
    s_waitcnt lgkmcnt(1)
    buffer_store_dwordx4 v[92:95], v250, s[8:11], s22 offen
    s_mov_b32 exec_hi, 0xff
    s_waitcnt lgkmcnt(0)
    buffer_store_dwordx4 v[96:99], v250, s[8:11], s23 offen
    s_mov_b32 exec_hi, -1
L_t_ny:
    ds_read_b64_tr_b16 v[204:205], v248 offset:44800
    ds_read_b64_tr_b16 v[206:207], v248 offset:46080
    ds_read_b64_tr_b16 v[208:209], v248 offset:44832
    ds_read_b64_tr_b16 v[210:211], v248 offset:46112
    ds_read_b64_tr_b16 v[212:213], v248 offset:44864
    ds_read_b64_tr_b16 v[214:215], v248 offset:46144
    ds_read_b64_tr_b16 v[216:217], v248 offset:44896
    ds_read_b64_tr_b16 v[218:219], v248 offset:46176
    ds_read_b64_tr_b16 v[220:221], v248 offset:44928
    ds_read_b64_tr_b16 v[222:223], v248 offset:46208
    ds_read_b64_tr_b16 v[184:185], v248 offset:38400
    ds_read_b64_tr_b16 v[186:187], v248 offset:39680
    ds_read_b64_tr_b16 v[188:189], v248 offset:38432
    ds_read_b64_tr_b16 v[190:191], v248 offset:39712
    ds_read_b64_tr_b16 v[192:193], v248 offset:38464
    ds_read_b64_tr_b16 v[194:195], v248 offset:39744
    ds_read_b64_tr_b16 v[196:197], v248 offset:38496
    ds_read_b64_tr_b16 v[198:199], v248 offset:39776
    ds_read_b64_tr_b16 v[200:201], v248 offset:38528
    ds_read_b64_tr_b16 v[202:203], v248 offset:39808
    ds_read_b64_tr_b16 v[164:165], v248 offset:32000
    ds_read_b64_tr_b16 v[166:167], v248 offset:33280
    ds_read_b64_tr_b16 v[168:169], v248 offset:32032
    ds_read_b64_tr_b16 v[170:171], v248 offset:33312
    ds_read_b64_tr_b16 v[172:173], v248 offset:32064
    ds_read_b64_tr_b16 v[174:175], v248 offset:33344
    ds_read_b64_tr_b16 v[176:177], v248 offset:32096
    ds_read_b64_tr_b16 v[178:179], v248 offset:33376
    ds_read_b64_tr_b16 v[180:181], v248 offset:32128
    ds_read_b64_tr_b16 v[182:183], v248 offset:33408
    ds_read_b64_tr_b16 v[144:145], v248 offset:25600
    ds_read_b64_tr_b16 v[146:147], v248 offset:26880
    ds_read_b64_tr_b16 v[148:149], v248 offset:25632
    ds_read_b64_tr_b16 v[150:151], v248 offset:26912
    ds_read_b64_tr_b16 v[152:153], v248 offset:25664
    ds_read_b64_tr_b16 v[154:155], v248 offset:26944
    ds_read_b64_tr_b16 v[156:157], v248 offset:25696
    ds_read_b64_tr_b16 v[158:159], v248 offset:26976
    ds_read_b64_tr_b16 v[160:161], v248 offset:25728
    ds_read_b64_tr_b16 v[162:163], v248 offset:27008
    ds_read_b64_tr_b16 v[88:89], v248 offset:19200
    ds_read_b64_tr_b16 v[90:91], v248 offset:20480
    ds_read_b64_tr_b16 v[92:93], v248 offset:19232
    ds_read_b64_tr_b16 v[94:95], v248 offset:20512
    ds_read_b64_tr_b16 v[96:97], v248 offset:19264
    ds_read_b64_tr_b16 v[98:99], v248 offset:20544
    ds_read_b64_tr_b16 v[100:101], v248 offset:19296
    ds_read_b64_tr_b16 v[102:103], v248 offset:20576
    ds_read_b64_tr_b16 v[104:105], v248 offset:19328
    ds_read_b64_tr_b16 v[106:107], v248 offset:20608
    ds_read_b64_tr_b16 v[68:69], v248 offset:12800
    ds_read_b64_tr_b16 v[70:71], v248 offset:14080
    ds_read_b64_tr_b16 v[72:73], v248 offset:12832
    ds_read_b64_tr_b16 v[74:75], v248 offset:14112
    ds_read_b64_tr_b16 v[76:77], v248 offset:12864
    ds_read_b64_tr_b16 v[78:79], v248 offset:14144
    ds_read_b64_tr_b16 v[80:81], v248 offset:12896
    ds_read_b64_tr_b16 v[82:83], v248 offset:14176
    ds_read_b64_tr_b16 v[84:85], v248 offset:12928
    ds_read_b64_tr_b16 v[86:87], v248 offset:14208
    ds_read_b64_tr_b16 v[48:49], v248 offset:6400
    ds_read_b64_tr_b16 v[50:51], v248 offset:7680
    ds_read_b64_tr_b16 v[52:53], v248 offset:6432
    ds_read_b64_tr_b16 v[54:55], v248 offset:7712
    ds_read_b64_tr_b16 v[56:57], v248 offset:6464
    ds_read_b64_tr_b16 v[58:59], v248 offset:7744
    ds_read_b64_tr_b16 v[60:61], v248 offset:6496
    ds_read_b64_tr_b16 v[62:63], v248 offset:7776
    ds_read_b64_tr_b16 v[64:65], v248 offset:6528
    ds_read_b64_tr_b16 v[66:67], v248 offset:7808
    ds_read_b64_tr_b16 v[28:29], v248 offset:0
    ds_read_b64_tr_b16 v[30:31], v248 offset:1280
    ds_read_b64_tr_b16 v[32:33], v248 offset:32
    ds_read_b64_tr_b16 v[34:35], v248 offset:1312
    ds_read_b64_tr_b16 v[36:37], v248 offset:64
    ds_read_b64_tr_b16 v[38:39], v248 offset:1344
    ds_read_b64_tr_b16 v[40:41], v248 offset:96
    ds_read_b64_tr_b16 v[42:43], v248 offset:1376
    ds_read_b64_tr_b16 v[44:45], v248 offset:128
    ds_read_b64_tr_b16 v[46:47], v248 offset:1408
    ds_read_b64_tr_b16 v[108:109], v249 offset:2560
    ds_read_b64_tr_b16 v[110:111], v249 offset:15360
    ds_read_b64_tr_b16 v[112:113], v249 offset:2592
    ds_read_b64_tr_b16 v[114:115], v249 offset:15392
    ds_read_b64_tr_b16 v[116:117], v249 offset:2624
    ds_read_b64_tr_b16 v[118:119], v249 offset:15424
    ds_read_b64_tr_b16 v[120:121], v249 offset:2656
    ds_read_b64_tr_b16 v[122:123], v249 offset:15456
    ds_read_b64_tr_b16 v[124:125], v249 offset:2688
    ds_read_b64_tr_b16 v[126:127], v249 offset:15488
    v_mov_b64 v[8:9], 0
    v_mov_b64 v[10:11], 0
    v_mov_b64 v[12:13], 0
    v_mov_b64 v[14:15], 0
    v_mov_b64 v[16:17], 0
    v_mov_b64 v[18:19], 0
    v_mov_b64 v[20:21], 0
    v_mov_b64 v[22:23], 0
    v_mov_b64 v[24:25], 0
    v_mov_b64 v[26:27], 0
L_t_loop:
    s_bitcmp0_b32 s29, 3
    s_cbranch_scc1 L_t_no3
    buffer_load_dwordx4 v[240:243], v5, s[12:15], s27 offen offset:2048 sc1
    buffer_load_dwordx4 v[244:247], v5, s[12:15], s27 offen offset:3072 sc1
    buffer_load_dwordx2 v[142:143], v1, s[12:15], s97 offen offset:1536 sc1
L_t_no3:
    s_bitcmp0_b32 s29, 2
    s_cbranch_scc1 L_t_no2
    buffer_load_dwordx4 v[232:235], v5, s[12:15], s27 offen offset:0 sc1
    buffer_load_dwordx4 v[236:239], v5, s[12:15], s27 offen offset:1024 sc1
    buffer_load_dwordx2 v[140:141], v1, s[12:15], s97 offen offset:1024 sc1
L_t_no2:
    s_bitcmp0_b32 s29, 1
    s_cbranch_scc1 L_t_no1
    buffer_load_dwordx4 v[224:227], v5, s[12:15], s96 offen offset:2048 sc1
    buffer_load_dwordx4 v[228:231], v5, s[12:15], s96 offen offset:3072 sc1
    buffer_load_dwordx2 v[138:139], v1, s[12:15], s97 offen offset:512 sc1
L_t_no1:
    s_bitcmp0_b32 s29, 0
    s_cbranch_scc1 L_t_no0
    buffer_load_dwordx4 v[128:131], v5, s[12:15], s96 offen offset:0 sc1
    buffer_load_dwordx4 v[132:135], v5, s[12:15], s96 offen offset:1024 sc1
    buffer_load_dwordx2 v[136:137], v1, s[12:15], s97 offen offset:0 sc1
L_t_no0:
    s_add_u32 s50, s50, 1
    s_cmp_gt_u32 s50, 262144
    s_cselect_b32 s31, 0, -1
    s_mov_b32 s28, s29
    s_waitcnt lgkmcnt(0)
    s_bitcmp0_b32 s28, 3
    s_cbranch_scc1 L_t_co3
    s_and_b32 s22, s28, 7
    s_bcnt1_i32_b32 s22, s22
    s_waitcnt vmcnt(9)
    s_cmp_eq_u32 s22, 3
    s_cbranch_scc1 L_t_w3
    s_waitcnt vmcnt(6)
    s_cmp_eq_u32 s22, 2
    s_cbranch_scc1 L_t_w3
    s_waitcnt vmcnt(3)
    s_cmp_eq_u32 s22, 1
    s_cbranch_scc1 L_t_w3
    s_waitcnt vmcnt(0)
L_t_w3:
    v_max3_u32 v4, v240, v241, v242
    v_max3_u32 v4, v4, v243, v244
    v_max3_u32 v4, v4, v245, v246
    v_max3_u32 v4, v4, v247, v142
    v_max_u32 v4, v4, v143
    v_and_b32 v4, s31, v4
    v_cmp_eq_u32 vcc, -1, v4
    s_cbranch_vccnz L_t_co3
    s_bitset0_b32 s29, 3
    v_mfma_f32_16x16x32_bf16 v[8:11], v[204:207], v[244:247], v[8:11]
    v_mfma_f32_16x16x32_bf16 v[12:15], v[208:211], v[244:247], v[12:15]
    v_mfma_f32_16x16x32_bf16 v[16:19], v[212:215], v[244:247], v[16:19]
    v_mfma_f32_16x16x32_bf16 v[20:23], v[216:219], v[244:247], v[20:23]
    v_mfma_f32_16x16x32_bf16 v[24:27], v[220:223], v[244:247], v[24:27]
    v_mfma_f32_16x16x32_bf16 v[8:11], v[184:187], v[240:243], v[8:11]
    v_mfma_f32_16x16x32_bf16 v[12:15], v[188:191], v[240:243], v[12:15]
    v_mfma_f32_16x16x32_bf16 v[16:19], v[192:195], v[240:243], v[16:19]
    v_mfma_f32_16x16x32_bf16 v[20:23], v[196:199], v[240:243], v[20:23]
    v_mfma_f32_16x16x32_bf16 v[24:27], v[200:203], v[240:243], v[24:27]
L_t_co3:
    s_bitcmp0_b32 s28, 2
    s_cbranch_scc1 L_t_co2
    s_and_b32 s22, s28, 3
    s_bcnt1_i32_b32 s22, s22
    s_waitcnt vmcnt(6)
    s_cmp_eq_u32 s22, 2
    s_cbranch_scc1 L_t_w2
    s_waitcnt vmcnt(3)
    s_cmp_eq_u32 s22, 1
    s_cbranch_scc1 L_t_w2
    s_waitcnt vmcnt(0)
L_t_w2:
    v_max3_u32 v4, v232, v233, v234
    v_max3_u32 v4, v4, v235, v236
    v_max3_u32 v4, v4, v237, v238
    v_max3_u32 v4, v4, v239, v140
    v_max_u32 v4, v4, v141
    v_and_b32 v4, s31, v4
    v_cmp_eq_u32 vcc, -1, v4
    s_cbranch_vccnz L_t_co2
    s_bitset0_b32 s29, 2
    v_mfma_f32_16x16x32_bf16 v[8:11], v[164:167], v[236:239], v[8:11]
    v_mfma_f32_16x16x32_bf16 v[12:15], v[168:171], v[236:239], v[12:15]
    v_mfma_f32_16x16x32_bf16 v[16:19], v[172:175], v[236:239], v[16:19]
    v_mfma_f32_16x16x32_bf16 v[20:23], v[176:179], v[236:239], v[20:23]
    v_mfma_f32_16x16x32_bf16 v[24:27], v[180:183], v[236:239], v[24:27]
    v_mfma_f32_16x16x32_bf16 v[8:11], v[144:147], v[232:235], v[8:11]
    v_mfma_f32_16x16x32_bf16 v[12:15], v[148:151], v[232:235], v[12:15]
    v_mfma_f32_16x16x32_bf16 v[16:19], v[152:155], v[232:235], v[16:19]
    v_mfma_f32_16x16x32_bf16 v[20:23], v[156:159], v[232:235], v[20:23]
    v_mfma_f32_16x16x32_bf16 v[24:27], v[160:163], v[232:235], v[24:27]
L_t_co2:
    s_bitcmp0_b32 s28, 1
    s_cbranch_scc1 L_t_co1
    s_and_b32 s22, s28, 1
    s_bcnt1_i32_b32 s22, s22
    s_waitcnt vmcnt(3)
    s_cmp_eq_u32 s22, 1
    s_cbranch_scc1 L_t_w1
    s_waitcnt vmcnt(0)
L_t_w1:
    v_max3_u32 v4, v224, v225, v226
    v_max3_u32 v4, v4, v227, v228
    v_max3_u32 v4, v4, v229, v230
    v_max3_u32 v4, v4, v231, v138
    v_max_u32 v4, v4, v139
    v_and_b32 v4, s31, v4
    v_cmp_eq_u32 vcc, -1, v4
    s_cbranch_vccnz L_t_co1
    s_bitset0_b32 s29, 1
    v_mfma_f32_16x16x32_bf16 v[8:11], v[88:91], v[228:231], v[8:11]
    v_mfma_f32_16x16x32_bf16 v[12:15], v[92:95], v[228:231], v[12:15]
    v_mfma_f32_16x16x32_bf16 v[16:19], v[96:99], v[228:231], v[16:19]
    v_mfma_f32_16x16x32_bf16 v[20:23], v[100:103], v[228:231], v[20:23]
    v_mfma_f32_16x16x32_bf16 v[24:27], v[104:107], v[228:231], v[24:27]
    v_mfma_f32_16x16x32_bf16 v[8:11], v[68:71], v[224:227], v[8:11]
    v_mfma_f32_16x16x32_bf16 v[12:15], v[72:75], v[224:227], v[12:15]
    v_mfma_f32_16x16x32_bf16 v[16:19], v[76:79], v[224:227], v[16:19]
    v_mfma_f32_16x16x32_bf16 v[20:23], v[80:83], v[224:227], v[20:23]
    v_mfma_f32_16x16x32_bf16 v[24:27], v[84:87], v[224:227], v[24:27]
L_t_co1:
    s_bitcmp0_b32 s28, 0
    s_cbranch_scc1 L_t_co0
    s_waitcnt vmcnt(0)
L_t_w0:
    v_max3_u32 v4, v128, v129, v130
    v_max3_u32 v4, v4, v131, v132
    v_max3_u32 v4, v4, v133, v134
    v_max3_u32 v4, v4, v135, v136
    v_max_u32 v4, v4, v137
    v_and_b32 v4, s31, v4
    v_cmp_eq_u32 vcc, -1, v4
    s_cbranch_vccnz L_t_co0
    s_bitset0_b32 s29, 0
    v_mfma_f32_16x16x32_bf16 v[8:11], v[48:51], v[132:135], v[8:11]
    v_mfma_f32_16x16x32_bf16 v[12:15], v[52:55], v[132:135], v[12:15]
    v_mfma_f32_16x16x32_bf16 v[16:19], v[56:59], v[132:135], v[16:19]
    v_mfma_f32_16x16x32_bf16 v[20:23], v[60:63], v[132:135], v[20:23]
    v_mfma_f32_16x16x32_bf16 v[24:27], v[64:67], v[132:135], v[24:27]
    v_mfma_f32_16x16x32_bf16 v[8:11], v[28:31], v[128:131], v[8:11]
    v_mfma_f32_16x16x32_bf16 v[12:15], v[32:35], v[128:131], v[12:15]
    v_mfma_f32_16x16x32_bf16 v[16:19], v[36:39], v[128:131], v[16:19]
    v_mfma_f32_16x16x32_bf16 v[20:23], v[40:43], v[128:131], v[20:23]
    v_mfma_f32_16x16x32_bf16 v[24:27], v[44:47], v[128:131], v[24:27]
L_t_co0:
    s_cmp_lg_u32 s29, 0
    s_cbranch_scc1 L_t_loop
    ds_read_b64_tr_b16 v[204:205], v249 offset:28160
    ds_read_b64_tr_b16 v[206:207], v249 offset:40960
    ds_read_b64_tr_b16 v[208:209], v249 offset:28192
    ds_read_b64_tr_b16 v[210:211], v249 offset:40992
    ds_read_b64_tr_b16 v[212:213], v249 offset:28224
    ds_read_b64_tr_b16 v[214:215], v249 offset:41024
    ds_read_b64_tr_b16 v[216:217], v249 offset:28256
    ds_read_b64_tr_b16 v[218:219], v249 offset:41056
    ds_read_b64_tr_b16 v[220:221], v249 offset:28288
    ds_read_b64_tr_b16 v[222:223], v249 offset:41088
    s_waitcnt lgkmcnt(10)
    v_mfma_f32_16x16x32_bf16 v[8:11], v[108:111], v[136:139], v[8:11]
    v_mfma_f32_16x16x32_bf16 v[12:15], v[112:115], v[136:139], v[12:15]
    v_mfma_f32_16x16x32_bf16 v[16:19], v[116:119], v[136:139], v[16:19]
    v_mfma_f32_16x16x32_bf16 v[20:23], v[120:123], v[136:139], v[20:23]
    v_mfma_f32_16x16x32_bf16 v[24:27], v[124:127], v[136:139], v[24:27]
    s_waitcnt lgkmcnt(8)
    v_mfma_f32_16x16x32_bf16 v[8:11], v[204:207], v[140:143], v[8:11]
    s_waitcnt lgkmcnt(6)
    v_mfma_f32_16x16x32_bf16 v[12:15], v[208:211], v[140:143], v[12:15]
    s_waitcnt lgkmcnt(4)
    v_mfma_f32_16x16x32_bf16 v[16:19], v[212:215], v[140:143], v[16:19]
    s_waitcnt lgkmcnt(2)
    v_mfma_f32_16x16x32_bf16 v[20:23], v[216:219], v[140:143], v[20:23]
    s_waitcnt lgkmcnt(0)
    v_mfma_f32_16x16x32_bf16 v[24:27], v[220:223], v[140:143], v[24:27]
    s_cmp_eq_u32 s48, 1
    s_cbranch_scc1 L_t_r1
    s_nop 3
    ds_write_b128 v6, v[8:11] offset:25856
    ds_write_b128 v6, v[12:15] offset:26880
    ds_write_b128 v6, v[16:19] offset:27904
    ds_write_b128 v6, v[20:23] offset:28928
    ds_write_b128 v6, v[24:27] offset:29952
    s_waitcnt lgkmcnt(0)
    s_barrier
    s_branch L_t_fin
L_t_r1:
    s_barrier
    ds_read_b128 v[128:131], v6 offset:25856
    ds_read_b128 v[132:135], v6 offset:26880
    ds_read_b128 v[136:139], v6 offset:27904
    ds_read_b128 v[140:143], v6 offset:28928
    ds_read_b128 v[144:147], v6 offset:29952
    s_waitcnt lgkmcnt(4)
    v_pk_add_f32 v[8:9], v[8:9], v[128:129]
    v_pk_add_f32 v[10:11], v[10:11], v[130:131]
    v_cvt_pk_bf16_f32 v8, v8, v9
    v_cvt_pk_bf16_f32 v9, v10, v11
    ds_write_b64 v251, v[8:9] offset:1280
    s_waitcnt lgkmcnt(4)
    v_pk_add_f32 v[12:13], v[12:13], v[132:133]
    v_pk_add_f32 v[14:15], v[14:15], v[134:135]
    v_cvt_pk_bf16_f32 v12, v12, v13
    v_cvt_pk_bf16_f32 v13, v14, v15
    ds_write_b64 v251, v[12:13] offset:1312
    s_waitcnt lgkmcnt(4)
    v_pk_add_f32 v[16:17], v[16:17], v[136:137]
    v_pk_add_f32 v[18:19], v[18:19], v[138:139]
    v_cvt_pk_bf16_f32 v16, v16, v17
    v_cvt_pk_bf16_f32 v17, v18, v19
    ds_write_b64 v251, v[16:17] offset:1344
    s_waitcnt lgkmcnt(4)
    v_pk_add_f32 v[20:21], v[20:21], v[140:141]
    v_pk_add_f32 v[22:23], v[22:23], v[142:143]
    v_cvt_pk_bf16_f32 v20, v20, v21
    v_cvt_pk_bf16_f32 v21, v22, v23
    ds_write_b64 v251, v[20:21] offset:1376
    s_waitcnt lgkmcnt(4)
    v_pk_add_f32 v[24:25], v[24:25], v[144:145]
    v_pk_add_f32 v[26:27], v[26:27], v[146:147]
    v_cvt_pk_bf16_f32 v24, v24, v25
    v_cvt_pk_bf16_f32 v25, v26, v27
    ds_write_b64 v251, v[24:25] offset:1408
    ds_read_b128 v[152:155], v6 offset:1280
    ds_read_b128 v[156:159], v6 offset:2240
    ds_read_b128 v[160:163], v6 offset:3200
    s_mov_b32 exec_hi, 0x0fffffff
    s_add_u32 s22, s98, 15360
    s_add_u32 s23, s98, 30720
    s_waitcnt lgkmcnt(2)
    buffer_store_dwordx4 v[152:155], v250, s[8:11], s98 offen
    s_waitcnt lgkmcnt(1)
    buffer_store_dwordx4 v[156:159], v250, s[8:11], s22 offen
    s_mov_b32 exec_hi, 0xff
    s_waitcnt lgkmcnt(0)
    buffer_store_dwordx4 v[160:163], v250, s[8:11], s23 offen
    s_mov_b32 exec_hi, -1
L_t_fin:
L_end:
    s_endpgm
L_tr_back:
    v_mov_b32 v220, 129536
    v_mov_b32 v222, 0
    v_mov_b32 v223, 0
    ds_write_b64 v220, v[222:223]
    s_waitcnt lgkmcnt(0)
    s_barrier
    s_cmp_lt_u32 s16, 4
    s_cbranch_scc1 L_w1
    s_branch L_h_ids
L_at_fc:
    v_mov_b32 v6, 0
    v_mov_b32 v7, s19
    s_mov_b64 exec, 1
    buffer_store_dword v7, v6, s[12:15], s36 offen sc1
    s_mov_b64 exec, -1
    s_mov_b32 s36, 0
    s_branch L_at_back
L_at_fallback:
    s_mov_b32 s47, 1
L_at_refill:
    s_waitcnt vmcnt(0) lgkmcnt(0)
    s_barrier
    s_lshr_b32 s22, s16, 1
    s_and_b32 s23, s16, 1
    s_mul_i32 s44, s22, 2080
    s_lshl_b32 s24, s23, 10
    s_add_u32 s44, s44, s24
    s_add_u32 s44, s44, 1280
    s_add_u32 s45, s44, 8320
    s_add_u32 s46, s44, 16640
    s_add_u32 s24, s22, s37
    s_lshl_b32 s24, s24, 10
    s_mul_i32 s23, s23, 3932160
    s_add_u32 s24, s24, s23
    s_add_u32 s40, s24, 655360
    s_add_u32 s42, s24, 822272
    s_cmp_eq_u32 s22, 0
    s_cselect_b32 s23, 0, 158720
    s_add_u32 s41, s40, s23
    s_add_u32 s41, s41, 4096
    v_and_b32 v3, 31, v2
    v_lshlrev_b32 v3, 3, v3
    v_lshrrev_b32 v5, 5, v2
    s_lshl_b32 s49, s48, 10
    s_lshl_b32 s22, s51, 1
    s_add_u32 s22, s22, s48
    s_lshl_b32 s22, s22, 8
    v_add_u32 v231, s22, v3
    v_lshl_add_u32 v232, v5, 12, v231
    v_mul_u32_u24 v225, 4160, v5
    s_add_u32 s22, s49, 1280
    v_add3_u32 v225, v225, v3, s22
    v_xor_b32 v229, 1, v5
    s_add_u32 s22, s22, 8256
    v_mad_u32_u24 v226, v229, s22, v3
    v_add_u32 v226, 64, v226
    v_bfe_u32 v3, v2, 2, 2
    v_lshl_add_u32 v5, v5, 2, v3
    v_and_b32 v4, 3, v2
    v_bfe_u32 v3, v2, 4, 1
    v_lshl_add_u32 v4, v3, 2, v4
    v_cmp_gt_u32 vcc, 5, v4
    v_mul_u32_u24 v4, 2080, v4
    s_add_u32 s22, s49, 11680
    v_add_u32 v4, s22, v4
    v_cndmask_b32 v227, 64, v4, vcc
    v_cndmask_b32 v228, 0, 1, vcc
    v_lshl_add_u32 v227, v5, 3, v227
    s_sub_u32 s24, 106, s16
    s_mul_i32 s94, s24, 7680
    s_lshr_b32 s22, s18, 2
    s_mul_i32 s22, s22, 160
    s_add_u32 s94, s94, s22
    s_mul_i32 s95, s24, 960
    s_add_u32 s95, s95, 61056
    s_mov_b32 m0, s44
    s_sub_u32 s22, s40, 491520
    buffer_load_dwordx4 v224, s[12:15], s22 offen sc1 lds
    s_mov_b32 m0, s45
    s_sub_u32 s22, s41, 491520
    buffer_load_dwordx4 v224, s[12:15], s22 offen sc1 lds
    s_cmp_ge_u32 s16, 4
    s_cbranch_scc1 L_at_f3
    s_mov_b32 m0, s46
    s_sub_u32 s22, s42, 491520
    buffer_load_dwordx4 v224, s[12:15], s22 offen sc1 lds
L_at_f3:
    s_waitcnt vmcnt(0)
    s_branch L_attn
L_at_maxpass:
    v_cndmask_b32 v20, 0, v20, vcc
    v_cndmask_b32 v21, 0, v21, vcc
    v_mov_b32 v56, 0xff800000
    v_cndmask_b32 v26, 0, v26, vcc
    v_cndmask_b32 v27, 0, v27, vcc
    v_mov_b32 v64, 0xff800000
L_at_mloop:
    ds_read_b64 v[28:29], v225 offset:0
    ds_read_b64 v[30:31], v225 offset:2080
    ds_read_b64 v[32:33], v226 offset:0
    s_waitcnt lgkmcnt(0)
    v_mfma_f32_32x32x16_bf16 v[72:87], v[28:31], v[16:19], 0
    v_mfma_f32_32x32x8_bf16 v[72:87], v[32:33], v[20:21], v[72:87]
    v_mfma_f32_32x32x16_bf16 v[88:103], v[28:31], v[22:25], 0
    v_mfma_f32_32x32x8_bf16 v[88:103], v[32:33], v[26:27], v[88:103]
    s_nop 7
    s_nop 3
    v_max3_f32 v56, v56, v72, v73
    v_max_f32 v56, v56, v74
    v_max3_f32 v56, v56, v75, v76
    v_max3_f32 v56, v56, v77, v78
    v_max3_f32 v56, v56, v79, v80
    v_max3_f32 v56, v56, v81, v82
    v_max3_f32 v56, v56, v83, v84
    v_max3_f32 v56, v56, v85, v86
    v_max_f32 v56, v56, v87
    v_max3_f32 v64, v64, v88, v89
    v_max_f32 v64, v64, v90
    v_max3_f32 v64, v64, v91, v92
    v_max3_f32 v64, v64, v93, v94
    v_max3_f32 v64, v64, v95, v96
    v_max3_f32 v64, v64, v97, v98
    v_max3_f32 v64, v64, v99, v100
    v_max3_f32 v64, v64, v101, v102
    v_max_f32 v64, v64, v103
    ds_read_b64 v[28:29], v225 offset:256
    ds_read_b64 v[30:31], v225 offset:2336
    ds_read_b64 v[32:33], v226 offset:256
    s_waitcnt lgkmcnt(0)
    v_mfma_f32_32x32x16_bf16 v[72:87], v[28:31], v[16:19], 0
    v_mfma_f32_32x32x8_bf16 v[72:87], v[32:33], v[20:21], v[72:87]
    v_mfma_f32_32x32x16_bf16 v[88:103], v[28:31], v[22:25], 0
    v_mfma_f32_32x32x8_bf16 v[88:103], v[32:33], v[26:27], v[88:103]
    s_nop 7
    s_nop 3
    v_max3_f32 v56, v56, v72, v73
    v_max_f32 v56, v56, v74
    v_max3_f32 v56, v56, v75, v76
    v_max3_f32 v56, v56, v77, v78
    v_max3_f32 v56, v56, v79, v80
    v_max3_f32 v56, v56, v81, v82
    v_max3_f32 v56, v56, v83, v84
    v_max3_f32 v56, v56, v85, v86
    v_max_f32 v56, v56, v87
    v_max3_f32 v64, v64, v88, v89
    v_max_f32 v64, v64, v90
    v_max3_f32 v64, v64, v91, v92
    v_max3_f32 v64, v64, v93, v94
    v_max3_f32 v64, v64, v95, v96
    v_max3_f32 v64, v64, v97, v98
    v_max3_f32 v64, v64, v99, v100
    v_max3_f32 v64, v64, v101, v102
    v_max_f32 v64, v64, v103
    ds_read_b64 v[28:29], v225 offset:512
    ds_read_b64 v[30:31], v225 offset:2592
    ds_read_b64 v[32:33], v226 offset:512
    s_waitcnt lgkmcnt(0)
    v_mfma_f32_32x32x16_bf16 v[72:87], v[28:31], v[16:19], 0
    v_mfma_f32_32x32x8_bf16 v[72:87], v[32:33], v[20:21], v[72:87]
    v_mfma_f32_32x32x16_bf16 v[88:103], v[28:31], v[22:25], 0
    v_mfma_f32_32x32x8_bf16 v[88:103], v[32:33], v[26:27], v[88:103]
    s_nop 7
    s_nop 3
    v_max3_f32 v56, v56, v72, v73
    v_max_f32 v56, v56, v74
    v_max3_f32 v56, v56, v75, v76
    v_max3_f32 v56, v56, v77, v78
    v_max3_f32 v56, v56, v79, v80
    v_max3_f32 v56, v56, v81, v82
    v_max3_f32 v56, v56, v83, v84
    v_max3_f32 v56, v56, v85, v86
    v_max_f32 v56, v56, v87
    v_max3_f32 v64, v64, v88, v89
    v_max_f32 v64, v64, v90
    v_max3_f32 v64, v64, v91, v92
    v_max3_f32 v64, v64, v93, v94
    v_max3_f32 v64, v64, v95, v96
    v_max3_f32 v64, v64, v97, v98
    v_max3_f32 v64, v64, v99, v100
    v_max3_f32 v64, v64, v101, v102
    v_max_f32 v64, v64, v103
    ds_read_b64 v[28:29], v225 offset:768
    ds_read_b64 v[30:31], v225 offset:2848
    ds_read_b64 v[32:33], v226 offset:768
    s_waitcnt lgkmcnt(0)
    v_mfma_f32_32x32x16_bf16 v[72:87], v[28:31], v[16:19], 0
    v_mfma_f32_32x32x8_bf16 v[72:87], v[32:33], v[20:21], v[72:87]
    v_mfma_f32_32x32x16_bf16 v[88:103], v[28:31], v[22:25], 0
    v_mfma_f32_32x32x8_bf16 v[88:103], v[32:33], v[26:27], v[88:103]
    s_nop 7
    s_nop 3
    v_max3_f32 v56, v56, v72, v73
    v_max_f32 v56, v56, v74
    v_max3_f32 v56, v56, v75, v76
    v_max3_f32 v56, v56, v77, v78
    v_max3_f32 v56, v56, v79, v80
    v_max3_f32 v56, v56, v81, v82
    v_max3_f32 v56, v56, v83, v84
    v_max3_f32 v56, v56, v85, v86
    v_max_f32 v56, v56, v87
    v_max3_f32 v64, v64, v88, v89
    v_max_f32 v64, v64, v90
    v_max3_f32 v64, v64, v91, v92
    v_max3_f32 v64, v64, v93, v94
    v_max3_f32 v64, v64, v95, v96
    v_max3_f32 v64, v64, v97, v98
    v_max3_f32 v64, v64, v99, v100
    v_max3_f32 v64, v64, v101, v102
    v_max_f32 v64, v64, v103
    s_add_u32 s30, s30, 1
    s_cmp_eq_u32 s30, 8
    s_cbranch_scc1 L_at_mdone
    s_barrier
    s_mov_b32 m0, s44
    s_nop 0
    buffer_load_dwordx4 v224, s[12:15], s40 offen sc1 lds
    s_add_u32 s40, s40, 491520
    s_mov_b32 m0, s45
    s_nop 0
    buffer_load_dwordx4 v224, s[12:15], s41 offen sc1 lds
    s_add_u32 s41, s41, 491520
    s_cmp_ge_u32 s16, 4
    s_cbranch_scc1 L_at_m3
    s_mov_b32 m0, s46
    s_nop 0
    buffer_load_dwordx4 v224, s[12:15], s42 offen sc1 lds
    s_add_u32 s42, s42, 491520
L_at_m3:
    s_waitcnt vmcnt(0)
    s_barrier
    s_branch L_at_mloop
L_at_mdone:
    s_lshl_b32 s22, s16, 10
    v_add_u32 v4, s22, v224
    v_xor_b32 v5, 4096, v4
    v_mov_b32 v57, v56
    s_nop 1
    v_permlane32_swap_b32 v56, v57
    v_max_f32 v56, v56, v57
    ds_write_b32 v4, v56 offset:43264
    v_mov_b32 v65, v64
    s_nop 1
    v_permlane32_swap_b32 v64, v65
    v_max_f32 v64, v64, v65
    ds_write_b32 v4, v64 offset:43268
    s_waitcnt lgkmcnt(0)
    s_barrier
    ds_read_b32 v72, v5 offset:43268
    ds_read_b32 v73, v5 offset:43264
    s_waitcnt lgkmcnt(0)
    v_max_f32 v56, v56, v72
    v_sub_f32 v56, 0, v56
    v_and_b32 v57, 0xffff0000, v56
    v_sub_f32 v58, v56, v57
    v_and_b32 v59, 0xffff0000, v58
    v_sub_f32 v58, v58, v59
    v_lshrrev_b32 v57, 16, v57
    v_or_b32 v57, v57, v59
    v_lshrrev_b32 v58, 16, v58
    v_cndmask_b32 v20, v57, v20, vcc
    v_cndmask_b32 v21, v58, v21, vcc
    v_max_f32 v64, v64, v73
    v_sub_f32 v64, 0, v64
    v_and_b32 v65, 0xffff0000, v64
    v_sub_f32 v66, v64, v65
    v_and_b32 v67, 0xffff0000, v66
    v_sub_f32 v66, v66, v67
    v_lshrrev_b32 v65, 16, v65
    v_or_b32 v65, v65, v67
    v_lshrrev_b32 v66, 16, v66
    v_cndmask_b32 v26, v65, v26, vcc
    v_cndmask_b32 v27, v66, v27, vcc
    s_mov_b32 s47, 2
    s_branch L_at_refill
.fill (1024 - ((. - concat_heads__ssm_conv_s4d__mha_block__prompt_kernel) % 1024))/4, 4, 0xbf810000
L_code_end:
.section .rodata,"a"
.p2align 6
.amdhsa_kernel concat_heads__ssm_conv_s4d__mha_block__prompt_kernel
  .amdhsa_next_free_vgpr 256
  .amdhsa_next_free_sgpr 102
  .amdhsa_accum_offset 256
  .amdhsa_group_segment_fixed_size 0
  .amdhsa_kernarg_size 104
  .amdhsa_user_sgpr_count 2
  .amdhsa_user_sgpr_kernarg_segment_ptr 1
  .amdhsa_system_sgpr_workgroup_id_x 1
.end_amdhsa_kernel
```
